```python
import torch

def _softmax(x, axis=-1):
    return torch.softmax(x, dim=axis)
def _gelu(x):
    return torch.nn.functional.gelu(x, approximate="tanh")
def _silu(x):
    return torch.nn.functional.silu(x)
def _sigmoid(x):
    return torch.sigmoid(x)
def _layernorm(x, axis=-1, eps=1e-5):
    m = x.mean(dim=axis, keepdim=True)
    v = x.var(dim=axis, keepdim=True, unbiased=False)
    return (x - m) / torch.sqrt(v + eps)
def _scatter_add(tgt, idx, src, axis=0):
    return tgt.clone().index_add_(axis, idx, src)
def _segment_sum(src, seg, n):
    out = torch.zeros((n,) + src.shape[1:], dtype=src.dtype)
    return out.index_add_(0, seg, src)
def _pad(x, pw):
    flat = tuple(v for pair in reversed(pw) for v in pair)
    return torch.nn.functional.pad(x, flat)

kernel_name = 'recurrent_scan__ssm_conv_h3__mixer_channel_mlp__prompt'

def setup_inputs():

    _w = (lambda a: (lambda t: t.to(torch.bfloat16) if t.is_floating_point() else t)(torch.as_tensor(a)))
    def _A_setup():
        B, S, D = 1, 2048, 512
        ks = 4
        return {
            "q": _w((lambda *s: torch.randn(*s, dtype=torch.bfloat16) * 0.05)(B, S, D)),
            "k": _w((lambda *s: torch.randn(*s, dtype=torch.bfloat16) * 0.8)(B, S, D)),
            "v": _w((lambda *s: torch.randn(*s, dtype=torch.bfloat16) * 0.8)(B, S, D)),
            "shift_k": _w((lambda *s: torch.randn(*s, dtype=torch.bfloat16) * 0.8)(D, ks) * 0.5),
            "ssm_k": _w((lambda *s: torch.randn(*s, dtype=torch.bfloat16) * 0.8)(D, S) * (1.0 / S ** 0.5)),
            "ssm_D": _w((lambda *s: torch.randn(*s, dtype=torch.bfloat16) * 0.8)(D)),
        }
    _A_in = _A_setup()

    def _B_setup():
        B, S, D, F = 1, 2048, 512, 1792
        return {
            "x": _w((lambda *s: torch.randn(*s, dtype=torch.bfloat16) * 0.05)(B, S, D)),
            "w1": _w((lambda *s: torch.randn(*s, dtype=torch.bfloat16) * 0.8)(D, F) * (D ** -0.5)),
            "b1": _w((lambda *s: torch.randn(*s, dtype=torch.bfloat16) * 0.4)(F)),
            "w2": _w((lambda *s: torch.randn(*s, dtype=torch.bfloat16) * 0.2)(F, D) * (F ** -0.5)),
            "b2": _w((lambda *s: torch.randn(*s, dtype=torch.bfloat16) * 0.2)(D)),
        }
    _B_in = _B_setup()

    return {
        "A_q": _A_in["q"],
        "A_k": _A_in["k"],
        "A_v": _A_in["v"],
        "A_shift_k": _A_in["shift_k"],
        "A_ssm_k": _A_in["ssm_k"],
        "A_ssm_D": _A_in["ssm_D"],
        "B_x": _B_in["x"],
        "B_w1": _B_in["w1"],
        "B_b1": _B_in["b1"],
        "B_w2": _B_in["w2"],
        "B_b2": _B_in["b2"],
    }

def reference(A_q, A_k, A_v, A_shift_k, A_ssm_k, A_ssm_D, B_x, B_w1, B_b1, B_w2, B_b2):
    def _A_ref(q, k, v, shift_k, ssm_k, ssm_D):
        B, S, D = q.shape
        ks = shift_k.shape[-1]
        k_pad = _pad(k, ((0, 0), (ks - 1, 0), (0, 0)))
        k_shift = torch.zeros_like(k)
        for t in range(ks):
            k_shift = k_shift + k_pad[:, t:t + S, :] * shift_k[:, ks - 1 - t][None, None, :]
        kv = k_shift * v
        L = 2 * S
        kv_pad = _pad(kv, ((0, 0), (0, S), (0, 0)))
        kf_pad = _pad(ssm_k, ((0, 0), (0, S)))
        kv_f = (lambda x, axes=(-2,-1): torch.fft.rfft2(x.float(), dim=axes))(kv_pad[:, None, :, :], axes=(1, 2))
        kf_f = (lambda x, axes=(-2,-1): torch.fft.rfft2(x.float(), dim=axes))(kf_pad[:, None, :], axes=(1, 2))
        kf_f = (lambda x, *d: x.permute(*d))(kf_f, 1, 2, 0)
        y_f = kv_f * kf_f[None, :, :, :]
        y = (lambda x, s, axes=(-2,-1): torch.fft.irfft2(x, s=s, dim=axes).to(torch.bfloat16))(y_f, (1, L), axes=(1, 2))[:, 0, :S, :]
        y = y + kv * ssm_D[None, None, :]
        return q * y

    def _B_ref(x, w1, b1, w2, b2):
        y = _layernorm(x, axis=-1)
        h = _gelu(torch.einsum("bsd,df->bsf", y, w1) + b1)
        return torch.einsum("bsf,fd->bsd", h, w2) + b2

    x = A_q
    xn = _layernorm(x, axis=-1)
    s = _A_ref(xn, A_k, A_v, A_shift_k, A_ssm_k, A_ssm_D)
    g = _silu(_B_ref(xn, B_w1, B_b1, B_w2, B_b2))
    return x + s * g
```

```asm
; @launch grid=(256,1,1) block=(512,1,1) lds=163840
.amdgcn_target "amdgcn-amd-amdhsa--gfx950"
.text
.globl recurrent_scan__ssm_conv_h3__mixer_channel_mlp__prompt_kernel
.p2align 8
.type recurrent_scan__ssm_conv_h3__mixer_channel_mlp__prompt_kernel,@function
recurrent_scan__ssm_conv_h3__mixer_channel_mlp__prompt_kernel:
  s_cmp_ge_u32 s2, 256
  s_cbranch_scc1 L_done
  s_load_dwordx16 s[16:31], s[0:1], 0
  s_load_dwordx8 s[32:39], s[0:1], 64
  s_load_dwordx4 s[40:43], s[0:1], 96
  s_memrealtime s[80:81]
  v_lshrrev_b32 v2, 6, v0
  v_and_b32 v1, 63, v0
  v_readfirstlane_b32 s7, v2
  s_and_b32 s9, s2, 7
  s_lshr_b32 s10, s2, 3
  v_mov_b32 v9, 0
  v_mov_b32 v11, 1
  v_mov_b32 v10, 119296
  v_lshl_add_u32 v3, v1, 2, v10
  ds_write_b32 v3, v9
  s_and_b32 s8, s7, 3
  s_mov_b32 s15, 0xffff0000
  s_lshr_b32 s3, s9, 1
  s_lshl_b32 s3, s3, 2
  s_and_b32 s4, s10, 3
  s_add_u32 s11, s3, s4
  s_and_b32 s3, s9, 1
  s_lshl_b32 s3, s3, 3
  s_lshr_b32 s14, s10, 2
  s_add_u32 s12, s3, s14
  s_lshl_b32 s3, s9, 2
  s_add_u32 s13, s3, s4
  v_lshrrev_b32 v2, 3, v1
  v_and_b32 v3, 7, v1
  v_lshlrev_b32 v4, 12, v2
  v_lshl_add_u32 v12, v3, 4, v4
  v_xor_b32 v13, 32, v12
  v_xor_b32 v14, 64, v12
  v_xor_b32 v15, 96, v12
  s_lshl_b32 s6, s10, 2
  s_add_u32 s6, s6, s8
  s_and_b32 s5, s8, 1
  s_cmp_ge_u32 s7, 4
  s_cbranch_scc1 L_helper
  s_setprio 2
  s_getpc_b64 s[94:95]
  s_cmp_ge_u32 s10, 2
  s_cbranch_scc1 L_nocpf
  v_lshlrev_b32 v3, 7, v0
  v_min_u32 v3, CODE_SPAN, v3
  global_load_dword v251, v3, s[94:95]
L_nocpf:
  s_lshl_b32 s3, s11, 7
  s_lshl_b32 s4, s8, 5
  s_add_u32 s7, s3, s4
  s_mov_b32 s3, 1198373
  s_mov_b32 s4, 3360
  s_mov_b32 s97, 14336
  v_lshlrev_b32 v2, 8, v1
  v_lshlrev_b32 v6, 4, v1
  v_mul_hi_u32_u24 v3, s3, v2
  v_mad_u32_u24 v240, v3, s4, v6
  v_bfe_u32 v4, v3, 2, 1
  v_bfe_u32 v5, v3, 3, 1
  v_sub_u32 v4, v4, v5
  v_mad_i32_i24 v240, v4, s97, v240
  v_add_u32 v2, 0x4000, v2
  v_mul_hi_u32_u24 v3, s3, v2
  v_mad_u32_u24 v241, v3, s4, v6
  v_bfe_u32 v4, v3, 2, 1
  v_bfe_u32 v5, v3, 3, 1
  v_sub_u32 v4, v4, v5
  v_mad_i32_i24 v241, v4, s97, v241
  v_add_u32 v2, 0x4000, v2
  v_mul_hi_u32_u24 v3, s3, v2
  v_mad_u32_u24 v242, v3, s4, v6
  v_bfe_u32 v4, v3, 2, 1
  v_bfe_u32 v5, v3, 3, 1
  v_sub_u32 v4, v4, v5
  v_mad_i32_i24 v242, v4, s97, v242
  v_add_u32 v2, 0x4000, v2
  v_mul_hi_u32_u24 v3, s3, v2
  v_mad_u32_u24 v243, v3, s4, v6
  v_bfe_u32 v4, v3, 2, 1
  v_bfe_u32 v5, v3, 3, 1
  v_sub_u32 v4, v4, v5
  v_mad_i32_i24 v243, v4, s97, v243
  v_add_u32 v6, 0x1000, v6
  v_add_u32 v2, 0x4000, v2
  v_mul_hi_u32_u24 v3, s3, v2
  v_mad_u32_u24 v244, v3, s4, v6
  v_bfe_u32 v4, v3, 2, 1
  v_bfe_u32 v5, v3, 3, 1
  v_sub_u32 v4, v4, v5
  v_mad_i32_i24 v244, v4, s97, v244
  v_add_u32 v2, 0x4000, v2
  v_mul_hi_u32_u24 v3, s3, v2
  v_mad_u32_u24 v245, v3, s4, v6
  v_bfe_u32 v4, v3, 2, 1
  v_bfe_u32 v5, v3, 3, 1
  v_sub_u32 v4, v4, v5
  v_mad_i32_i24 v245, v4, s97, v245
  v_add_u32 v2, 0x4000, v2
  v_mul_hi_u32_u24 v3, s3, v2
  v_mad_u32_u24 v246, v3, s4, v6
  v_bfe_u32 v4, v3, 2, 1
  v_bfe_u32 v5, v3, 3, 1
  v_sub_u32 v4, v4, v5
  v_mad_i32_i24 v246, v4, s97, v246
  s_mul_i32 s87, s12, 224
  s_mul_i32 s3, s8, 114688
  s_add_u32 s87, s87, s3
  s_mul_i32 s100, s8, 7168
  s_lshl_b32 s85, s7, 10
  s_lshr_b32 s3, s8, 1
  s_lshl_b32 s3, s3, 7
  s_add_u32 s85, s85, s3
  s_lshl_b32 s86, s8, 13
  s_add_u32 s86, s86, 86016
  s_waitcnt lgkmcnt(0)
  s_barrier
  s_mov_b32 s44, s16
  s_and_b32 s45, s17, 0xffff
  s_mov_b32 s46, 0x200000
  s_mov_b32 s47, 0x20000
  s_add_u32 m0, s86, 0
  s_xor_b32 s29, s85, 0
  buffer_load_dwordx4 v12, s[44:47], s29 offen offset:0 lds
  buffer_load_dwordx4 v13, s[44:47], s29 offen offset:1024 lds
  buffer_load_dwordx4 v14, s[44:47], s29 offen offset:2048 lds
  buffer_load_dwordx4 v15, s[44:47], s29 offen offset:3072 lds
  s_mov_b32 s48, s30
  s_and_b32 s49, s31, 0xffff
  s_mov_b32 s50, 0x1c0000
  s_mov_b32 s51, 0x20000
  s_add_u32 m0, s100, 0
  s_nop 0
  buffer_load_dwordx4 v240, s[48:51], s87 offen offset:0 lds
  buffer_load_dwordx4 v241, s[48:51], s87 offen offset:1024 lds
  buffer_load_dwordx4 v242, s[48:51], s87 offen offset:2048 lds
  buffer_load_dwordx4 v243, s[48:51], s87 offen offset:3072 lds
  s_add_u32 m0, s100, 4096
  s_nop 0
  buffer_load_dwordx4 v244, s[48:51], s87 offen offset:0 lds
  buffer_load_dwordx4 v245, s[48:51], s87 offen offset:1024 lds
  buffer_load_dwordx4 v246, s[48:51], s87 offen offset:2048 lds
  s_mov_b32 s30, 600000
  s_mov_b32 s52, s42
  s_and_b32 s53, s43, 0xffff
  s_mov_b32 s54, 0x10000000
  s_mov_b32 s55, 0x20000
  v_lshrrev_b32 v2, 5, v1
  v_lshlrev_b32 v2, 4, v2
  v_bfe_u32 v4, v1, 4, 1
  v_lshl_add_u32 v2, v4, 2, v2
  v_bfe_u32 v4, v1, 2, 2
  v_add_u32 v2, v4, v2
  v_mul_u32_u24 v2, 224, v2
  v_and_b32 v5, 3, v1
  v_lshl_add_u32 v2, v5, 3, v2
  s_xor_b32 s3, s8, 0
  s_mul_i32 s3, s3, 7168
  v_add_u32 v26, s3, v2
  s_xor_b32 s3, s8, 1
  s_mul_i32 s3, s3, 7168
  v_add_u32 v27, s3, v2
  s_xor_b32 s3, s8, 2
  s_mul_i32 s3, s3, 7168
  v_add_u32 v28, s3, v2
  s_xor_b32 s3, s8, 3
  s_mul_i32 s3, s3, 7168
  v_add_u32 v29, s3, v2
  v_lshlrev_b32 v3, 10, v4
  v_lshl_add_u32 v3, v4, 5, v3
  v_lshrrev_b32 v2, 4, v1
  v_lshl_add_u32 v3, v2, 7, v3
  v_lshl_add_u32 v3, v5, 3, v3
  s_lshl_b32 s82, s8, 12
  v_add_u32 v3, s82, v3
  v_xor_b32 v18, 0, v3
  v_add_u32 v22, 0x10000, v18
  v_xor_b32 v19, 32, v3
  v_add_u32 v23, 0x10000, v19
  v_xor_b32 v20, 64, v3
  v_add_u32 v24, 0x10000, v20
  v_xor_b32 v21, 96, v3
  v_add_u32 v25, 0x10000, v21
  v_lshlrev_b32 v3, 3, v5
  v_add_u32 v3, v4, v3
  v_lshlrev_b32 v3, 7, v3
  v_lshlrev_b32 v5, 1, v5
  v_xor_b32 v5, v2, v5
  v_lshl_add_u32 v3, v5, 4, v3
  s_lshl_b32 s3, s5, 6
  v_xor_b32 v3, s3, v3
  s_lshl_b32 s3, s8, 13
  s_add_u32 s3, s3, 86016
  v_add_u32 v30, s3, v3
  v_xor_b32 v31, 64, v30
  v_mov_b32 v140, 0x3f803f80
  v_mov_b32 v141, 0x3f803f80
  v_mov_b32 v142, 0x3f803f80
  v_mov_b32 v143, 0x3f803f80
  s_mov_b32 vcc_lo, 0x10001
  s_mov_b32 vcc_hi, 0x10001
  v_cndmask_b32 v144, 0, v140, vcc
  v_cndmask_b32 v145, 0, v140, vcc
  v_cndmask_b32 v146, 0, v140, vcc
  v_cndmask_b32 v147, 0, v140, vcc
  s_mov_b32 vcc_lo, 0x20002
  s_mov_b32 vcc_hi, 0x20002
  v_cndmask_b32 v148, 0, v140, vcc
  v_cndmask_b32 v149, 0, v140, vcc
  v_cndmask_b32 v150, 0, v140, vcc
  v_cndmask_b32 v151, 0, v140, vcc
  s_mov_b32 vcc_lo, 0x40004
  s_mov_b32 vcc_hi, 0x40004
  v_cndmask_b32 v152, 0, v140, vcc
  v_cndmask_b32 v153, 0, v140, vcc
  v_cndmask_b32 v154, 0, v140, vcc
  v_cndmask_b32 v155, 0, v140, vcc
  s_mov_b32 vcc_lo, 0x80008
  s_mov_b32 vcc_hi, 0x80008
  v_cndmask_b32 v156, 0, v140, vcc
  v_cndmask_b32 v157, 0, v140, vcc
  v_cndmask_b32 v158, 0, v140, vcc
  v_cndmask_b32 v159, 0, v140, vcc
  s_mov_b32 vcc_lo, 0x100010
  s_mov_b32 vcc_hi, 0x100010
  v_cndmask_b32 v160, 0, v140, vcc
  v_cndmask_b32 v161, 0, v140, vcc
  v_cndmask_b32 v162, 0, v140, vcc
  v_cndmask_b32 v163, 0, v140, vcc
  s_mov_b32 vcc_lo, 0x200020
  s_mov_b32 vcc_hi, 0x200020
  v_cndmask_b32 v164, 0, v140, vcc
  v_cndmask_b32 v165, 0, v140, vcc
  v_cndmask_b32 v166, 0, v140, vcc
  v_cndmask_b32 v167, 0, v140, vcc
  s_mov_b32 vcc_lo, 0x400040
  s_mov_b32 vcc_hi, 0x400040
  v_cndmask_b32 v168, 0, v140, vcc
  v_cndmask_b32 v169, 0, v140, vcc
  v_cndmask_b32 v170, 0, v140, vcc
  v_cndmask_b32 v171, 0, v140, vcc
  v_lshlrev_b32 v32, 4, v2
  v_add_u32 v32, 119552, v32
  s_lshl_b32 s97, s8, 9
  v_add_u32 v33, s97, v32
  v_min_u32 v2, 27, v1
  v_lshlrev_b32 v34, 4, v2
  v_add_u32 v34, 119552, v34
  s_mul_i32 s3, s12, 224
  v_lshl_add_u32 v236, v2, 3, s3
  s_mov_b32 s72, s34
  s_and_b32 s73, s35, 0xffff
  s_mov_b32 s74, 0x1c0000
  s_mov_b32 s75, 0x20000
  s_mul_i32 s83, s8, 458752
  s_lshl_b32 s3, s14, 7
  s_add_u32 s83, s83, s3
  s_add_u32 m0, s86, 4096
  s_xor_b32 s29, s85, 128
  buffer_load_dwordx4 v12, s[44:47], s29 offen offset:0 lds
  buffer_load_dwordx4 v13, s[44:47], s29 offen offset:1024 lds
  buffer_load_dwordx4 v14, s[44:47], s29 offen offset:2048 lds
  buffer_load_dwordx4 v15, s[44:47], s29 offen offset:3072 lds
  s_waitcnt vmcnt(11)
  ds_read_b128 v[172:175], v30 offset:0
  ds_read_b128 v[176:179], v30 offset:512
  ds_read_b128 v[180:183], v31 offset:0
  ds_read_b128 v[184:187], v31 offset:512
  s_waitcnt vmcnt(4)
  s_mov_b64 exec, 1
  ds_add_u32 v10, v11 offset:0
  s_mov_b64 exec, -1
  s_waitcnt lgkmcnt(1)
  s_add_u32 m0, s86, 0
  s_xor_b32 s29, s85, 256
  buffer_load_dwordx4 v12, s[44:47], s29 offen offset:0 lds
  buffer_load_dwordx4 v13, s[44:47], s29 offen offset:1024 lds
  buffer_load_dwordx4 v14, s[44:47], s29 offen offset:2048 lds
  buffer_load_dwordx4 v15, s[44:47], s29 offen offset:3072 lds
Lc1:
  ds_read_b32 v8, v10 offset:0
  s_waitcnt lgkmcnt(0)
  v_cmp_gt_u32 vcc, 4, v8
  s_cbranch_vccz Lc1_x
  s_sleep 1
  s_sub_u32 s30, s30, 1
  s_cmp_gt_i32 s30, 0
  s_cbranch_scc1 Lc1
Lc1_x:
  ds_read_b64_tr_b16 v[40:41], v26 offset:0
  ds_read_b64_tr_b16 v[42:43], v26 offset:1792
  ds_read_b64_tr_b16 v[44:45], v26 offset:32
  ds_read_b64_tr_b16 v[46:47], v26 offset:1824
  ds_read_b64_tr_b16 v[48:49], v26 offset:64
  ds_read_b64_tr_b16 v[50:51], v26 offset:1856
  ds_read_b64_tr_b16 v[52:53], v26 offset:96
  ds_read_b64_tr_b16 v[54:55], v26 offset:1888
  ds_read_b64_tr_b16 v[56:57], v26 offset:128
  ds_read_b64_tr_b16 v[58:59], v26 offset:1920
  ds_read_b64_tr_b16 v[60:61], v26 offset:160
  ds_read_b64_tr_b16 v[62:63], v26 offset:1952
  ds_read_b64_tr_b16 v[64:65], v26 offset:192
  ds_read_b64_tr_b16 v[66:67], v26 offset:1984
  s_waitcnt lgkmcnt(8)
  v_mfma_f32_16x16x32_bf16 v[84:87], v[40:43], v[172:175], 0
  s_add_u32 m0, s100, 28672
  s_add_u32 s87, s87, 458752
  buffer_load_dwordx4 v240, s[48:51], s87 offen offset:0 lds
  v_mfma_f32_16x16x32_bf16 v[88:91], v[40:43], v[176:179], 0
  v_mfma_f32_16x16x32_bf16 v[252:255], v[40:43], v[144:147], 0
  ds_read_b64_tr_b16 v[40:41], v27 offset:0
  v_mfma_f32_16x16x32_bf16 v[92:95], v[44:47], v[172:175], 0
  ds_read_b64_tr_b16 v[42:43], v27 offset:1792
  buffer_load_dwordx4 v241, s[48:51], s87 offen offset:1024 lds
  v_mfma_f32_16x16x32_bf16 v[96:99], v[44:47], v[176:179], 0
  v_mfma_f32_16x16x32_bf16 v[252:255], v[44:47], v[148:151], v[252:255]
  ds_read_b64_tr_b16 v[44:45], v27 offset:32
  v_mfma_f32_16x16x32_bf16 v[100:103], v[48:51], v[172:175], 0
  ds_read_b64_tr_b16 v[46:47], v27 offset:1824
  v_mfma_f32_16x16x32_bf16 v[104:107], v[48:51], v[176:179], 0
  buffer_load_dwordx4 v242, s[48:51], s87 offen offset:2048 lds
  v_mfma_f32_16x16x32_bf16 v[252:255], v[48:51], v[152:155], v[252:255]
  ds_read_b64_tr_b16 v[48:49], v27 offset:64
  s_waitcnt lgkmcnt(9)
  v_mfma_f32_16x16x32_bf16 v[108:111], v[52:55], v[172:175], 0
  ds_read_b64_tr_b16 v[50:51], v27 offset:1856
  v_mfma_f32_16x16x32_bf16 v[112:115], v[52:55], v[176:179], 0
  buffer_load_dwordx4 v243, s[48:51], s87 offen offset:3072 lds
  v_mfma_f32_16x16x32_bf16 v[252:255], v[52:55], v[156:159], v[252:255]
  ds_read_b64_tr_b16 v[52:53], v27 offset:96
  v_mfma_f32_16x16x32_bf16 v[116:119], v[56:59], v[172:175], 0
  ds_read_b64_tr_b16 v[54:55], v27 offset:1888
  v_mfma_f32_16x16x32_bf16 v[120:123], v[56:59], v[176:179], 0
  v_mfma_f32_16x16x32_bf16 v[252:255], v[56:59], v[160:163], v[252:255]
  ds_read_b64_tr_b16 v[56:57], v27 offset:128
  s_add_u32 m0, s100, 32768
  s_nop 0
  buffer_load_dwordx4 v244, s[48:51], s87 offen offset:0 lds
  s_waitcnt lgkmcnt(9)
  v_mfma_f32_16x16x32_bf16 v[124:127], v[60:63], v[172:175], 0
  ds_read_b64_tr_b16 v[58:59], v27 offset:1920
  v_mfma_f32_16x16x32_bf16 v[128:131], v[60:63], v[176:179], 0
  v_mfma_f32_16x16x32_bf16 v[252:255], v[60:63], v[164:167], v[252:255]
  ds_read_b64_tr_b16 v[60:61], v27 offset:160
  buffer_load_dwordx4 v245, s[48:51], s87 offen offset:1024 lds
  v_mfma_f32_16x16x32_bf16 v[132:135], v[64:67], v[172:175], 0
  ds_read_b64_tr_b16 v[62:63], v27 offset:1952
  v_mfma_f32_16x16x32_bf16 v[136:139], v[64:67], v[176:179], 0
  v_mfma_f32_16x16x32_bf16 v[252:255], v[64:67], v[168:171], v[252:255]
  ds_read_b64_tr_b16 v[64:65], v27 offset:192
  v_mfma_f32_16x16x32_bf16 v[68:71], v[172:175], v[172:175], 0
  ds_read_b64_tr_b16 v[66:67], v27 offset:1984
  buffer_load_dwordx4 v246, s[48:51], s87 offen offset:2048 lds
  v_mfma_f32_16x16x32_bf16 v[72:75], v[176:179], v[176:179], 0
  v_mfma_f32_16x16x32_bf16 v[76:79], v[140:143], v[172:175], 0
  v_mfma_f32_16x16x32_bf16 v[80:83], v[140:143], v[176:179], 0
  s_waitcnt lgkmcnt(8)
  v_mfma_f32_16x16x32_bf16 v[84:87], v[40:43], v[180:183], v[84:87]
  s_waitcnt vmcnt(11)
  ds_read_b128 v[188:191], v30 offset:4096
  v_mfma_f32_16x16x32_bf16 v[88:91], v[40:43], v[184:187], v[88:91]
  ds_read_b64_tr_b16 v[40:41], v28 offset:0
  ds_read_b128 v[192:195], v30 offset:4608
  v_mfma_f32_16x16x32_bf16 v[92:95], v[44:47], v[180:183], v[92:95]
  ds_read_b64_tr_b16 v[42:43], v28 offset:1792
  v_mfma_f32_16x16x32_bf16 v[96:99], v[44:47], v[184:187], v[96:99]
  ds_read_b64_tr_b16 v[44:45], v28 offset:32
  ds_read_b128 v[196:199], v31 offset:4096
  v_mfma_f32_16x16x32_bf16 v[100:103], v[48:51], v[180:183], v[100:103]
  ds_read_b64_tr_b16 v[46:47], v28 offset:1824
  ds_read_b128 v[200:203], v31 offset:4608
  v_mfma_f32_16x16x32_bf16 v[104:107], v[48:51], v[184:187], v[104:107]
  ds_read_b64_tr_b16 v[48:49], v28 offset:64
  s_waitcnt lgkmcnt(13)
  v_mfma_f32_16x16x32_bf16 v[108:111], v[52:55], v[180:183], v[108:111]
  ds_read_b64_tr_b16 v[50:51], v28 offset:1856
  s_waitcnt lgkmcnt(2)
  s_add_u32 m0, s86, 4096
  s_xor_b32 s29, s85, 384
  buffer_load_dwordx4 v12, s[44:47], s29 offen offset:0 lds
  v_mfma_f32_16x16x32_bf16 v[112:115], v[52:55], v[184:187], v[112:115]
  ds_read_b64_tr_b16 v[52:53], v28 offset:96
  buffer_load_dwordx4 v13, s[44:47], s29 offen offset:1024 lds
  v_mfma_f32_16x16x32_bf16 v[116:119], v[56:59], v[180:183], v[116:119]
  ds_read_b64_tr_b16 v[54:55], v28 offset:1888
  v_mfma_f32_16x16x32_bf16 v[120:123], v[56:59], v[184:187], v[120:123]
  ds_read_b64_tr_b16 v[56:57], v28 offset:128
  buffer_load_dwordx4 v14, s[44:47], s29 offen offset:2048 lds
  v_mfma_f32_16x16x32_bf16 v[124:127], v[60:63], v[180:183], v[124:127]
  ds_read_b64_tr_b16 v[58:59], v28 offset:1920
  buffer_load_dwordx4 v15, s[44:47], s29 offen offset:3072 lds
  v_mfma_f32_16x16x32_bf16 v[128:131], v[60:63], v[184:187], v[128:131]
  ds_read_b64_tr_b16 v[60:61], v28 offset:160
  v_mfma_f32_16x16x32_bf16 v[132:135], v[64:67], v[180:183], v[132:135]
  ds_read_b64_tr_b16 v[62:63], v28 offset:1952
  s_add_u32 m0, s100, 57344
  s_add_u32 s87, s87, 458752
  buffer_load_dwordx4 v240, s[48:51], s87 offen offset:0 lds
  v_mfma_f32_16x16x32_bf16 v[136:139], v[64:67], v[184:187], v[136:139]
  ds_read_b64_tr_b16 v[64:65], v28 offset:192
  buffer_load_dwordx4 v241, s[48:51], s87 offen offset:1024 lds
  v_mfma_f32_16x16x32_bf16 v[68:71], v[180:183], v[180:183], v[68:71]
  ds_read_b64_tr_b16 v[66:67], v28 offset:1984
  v_mfma_f32_16x16x32_bf16 v[72:75], v[184:187], v[184:187], v[72:75]
  buffer_load_dwordx4 v242, s[48:51], s87 offen offset:2048 lds
  v_mfma_f32_16x16x32_bf16 v[76:79], v[140:143], v[180:183], v[76:79]
  buffer_load_dwordx4 v243, s[48:51], s87 offen offset:3072 lds
  v_mfma_f32_16x16x32_bf16 v[80:83], v[140:143], v[184:187], v[80:83]
  s_waitcnt lgkmcnt(8)
  v_mfma_f32_16x16x32_bf16 v[84:87], v[40:43], v[188:191], v[84:87]
  s_waitcnt vmcnt(8)
  s_mov_b64 exec, 1
  ds_add_u32 v10, v11 offset:4
  s_mov_b64 exec, -1
  v_mfma_f32_16x16x32_bf16 v[88:91], v[40:43], v[192:195], v[88:91]
  ds_read_b64_tr_b16 v[40:41], v29 offset:0
  v_mfma_f32_16x16x32_bf16 v[92:95], v[44:47], v[188:191], v[92:95]
  ds_read_b64_tr_b16 v[42:43], v29 offset:1792
  ds_read_b128 v[204:207], v30 offset:0
  v_mfma_f32_16x16x32_bf16 v[96:99], v[44:47], v[192:195], v[96:99]
  ds_read_b64_tr_b16 v[44:45], v29 offset:32
  v_mfma_f32_16x16x32_bf16 v[100:103], v[48:51], v[188:191], v[100:103]
  ds_read_b64_tr_b16 v[46:47], v29 offset:1824
  ds_read_b128 v[208:211], v30 offset:512
  v_mfma_f32_16x16x32_bf16 v[104:107], v[48:51], v[192:195], v[104:107]
  ds_read_b64_tr_b16 v[48:49], v29 offset:64
  s_waitcnt lgkmcnt(12)
  v_mfma_f32_16x16x32_bf16 v[108:111], v[52:55], v[188:191], v[108:111]
  ds_read_b64_tr_b16 v[50:51], v29 offset:1856
  ds_read_b128 v[212:215], v31 offset:0
  v_mfma_f32_16x16x32_bf16 v[112:115], v[52:55], v[192:195], v[112:115]
  ds_read_b64_tr_b16 v[52:53], v29 offset:96
  v_mfma_f32_16x16x32_bf16 v[116:119], v[56:59], v[188:191], v[116:119]
  ds_read_b64_tr_b16 v[54:55], v29 offset:1888
  ds_read_b128 v[216:219], v31 offset:512
  v_mfma_f32_16x16x32_bf16 v[120:123], v[56:59], v[192:195], v[120:123]
  ds_read_b64_tr_b16 v[56:57], v29 offset:128
  s_waitcnt lgkmcnt(14)
  v_mfma_f32_16x16x32_bf16 v[124:127], v[60:63], v[188:191], v[124:127]
  ds_read_b64_tr_b16 v[58:59], v29 offset:1920
  s_waitcnt lgkmcnt(2)
  s_add_u32 m0, s86, 0
  s_xor_b32 s29, s85, 512
  buffer_load_dwordx4 v12, s[44:47], s29 offen offset:0 lds
  v_mfma_f32_16x16x32_bf16 v[128:131], v[60:63], v[192:195], v[128:131]
  ds_read_b64_tr_b16 v[60:61], v29 offset:160
  v_mfma_f32_16x16x32_bf16 v[132:135], v[64:67], v[188:191], v[132:135]
  ds_read_b64_tr_b16 v[62:63], v29 offset:1952
  buffer_load_dwordx4 v13, s[44:47], s29 offen offset:1024 lds
  v_mfma_f32_16x16x32_bf16 v[136:139], v[64:67], v[192:195], v[136:139]
  ds_read_b64_tr_b16 v[64:65], v29 offset:192
  v_mfma_f32_16x16x32_bf16 v[68:71], v[188:191], v[188:191], v[68:71]
  ds_read_b64_tr_b16 v[66:67], v29 offset:1984
  buffer_load_dwordx4 v14, s[44:47], s29 offen offset:2048 lds
  v_mfma_f32_16x16x32_bf16 v[72:75], v[192:195], v[192:195], v[72:75]
  v_mfma_f32_16x16x32_bf16 v[76:79], v[140:143], v[188:191], v[76:79]
  buffer_load_dwordx4 v15, s[44:47], s29 offen offset:3072 lds
  v_mfma_f32_16x16x32_bf16 v[80:83], v[140:143], v[192:195], v[80:83]
Lc2:
  ds_read_b32 v8, v10 offset:4
  s_waitcnt lgkmcnt(0)
  v_cmp_gt_u32 vcc, 4, v8
  s_cbranch_vccz Lc2_x
  s_sub_u32 s30, s30, 1
  s_cmp_gt_i32 s30, 0
  s_cbranch_scc1 Lc2
Lc2_x:
  v_mfma_f32_16x16x32_bf16 v[84:87], v[40:43], v[196:199], v[84:87]
  s_add_u32 m0, s100, 61440
  s_nop 0
  buffer_load_dwordx4 v244, s[48:51], s87 offen offset:0 lds
  v_mfma_f32_16x16x32_bf16 v[88:91], v[40:43], v[200:203], v[88:91]
  ds_read_b64_tr_b16 v[40:41], v26 offset:28672
  buffer_load_dwordx4 v245, s[48:51], s87 offen offset:1024 lds
  v_mfma_f32_16x16x32_bf16 v[92:95], v[44:47], v[196:199], v[92:95]
  ds_read_b64_tr_b16 v[42:43], v26 offset:30464
  v_mfma_f32_16x16x32_bf16 v[96:99], v[44:47], v[200:203], v[96:99]
  ds_read_b64_tr_b16 v[44:45], v26 offset:28704
  buffer_load_dwordx4 v246, s[48:51], s87 offen offset:2048 lds
  v_mfma_f32_16x16x32_bf16 v[100:103], v[48:51], v[196:199], v[100:103]
  ds_read_b64_tr_b16 v[46:47], v26 offset:30496
  s_waitcnt vmcnt(11)
  ds_read_b128 v[220:223], v30 offset:4096
  v_mfma_f32_16x16x32_bf16 v[104:107], v[48:51], v[200:203], v[104:107]
  ds_read_b64_tr_b16 v[48:49], v26 offset:28736
  v_mfma_f32_16x16x32_bf16 v[108:111], v[52:55], v[196:199], v[108:111]
  ds_read_b64_tr_b16 v[50:51], v26 offset:30528
  ds_read_b128 v[224:227], v30 offset:4608
  v_mfma_f32_16x16x32_bf16 v[112:115], v[52:55], v[200:203], v[112:115]
  ds_read_b64_tr_b16 v[52:53], v26 offset:28768
  v_mfma_f32_16x16x32_bf16 v[116:119], v[56:59], v[196:199], v[116:119]
  ds_read_b64_tr_b16 v[54:55], v26 offset:30560
  ds_read_b128 v[228:231], v31 offset:4096
  v_mfma_f32_16x16x32_bf16 v[120:123], v[56:59], v[200:203], v[120:123]
  ds_read_b64_tr_b16 v[56:57], v26 offset:28800
  ds_read_b128 v[232:235], v31 offset:4608
  v_mfma_f32_16x16x32_bf16 v[124:127], v[60:63], v[196:199], v[124:127]
  ds_read_b64_tr_b16 v[58:59], v26 offset:30592
  v_mfma_f32_16x16x32_bf16 v[128:131], v[60:63], v[200:203], v[128:131]
  ds_read_b64_tr_b16 v[60:61], v26 offset:28832
  s_waitcnt lgkmcnt(2)
  s_add_u32 m0, s86, 4096
  s_xor_b32 s29, s85, 640
  buffer_load_dwordx4 v12, s[44:47], s29 offen offset:0 lds
  v_mfma_f32_16x16x32_bf16 v[132:135], v[64:67], v[196:199], v[132:135]
  ds_read_b64_tr_b16 v[62:63], v26 offset:30624
  v_mfma_f32_16x16x32_bf16 v[136:139], v[64:67], v[200:203], v[136:139]
  ds_read_b64_tr_b16 v[64:65], v26 offset:28864
  buffer_load_dwordx4 v13, s[44:47], s29 offen offset:1024 lds
  v_mfma_f32_16x16x32_bf16 v[68:71], v[196:199], v[196:199], v[68:71]
  ds_read_b64_tr_b16 v[66:67], v26 offset:30656
  buffer_load_dwordx4 v14, s[44:47], s29 offen offset:2048 lds
  v_mfma_f32_16x16x32_bf16 v[72:75], v[200:203], v[200:203], v[72:75]
  v_mfma_f32_16x16x32_bf16 v[76:79], v[140:143], v[196:199], v[76:79]
  buffer_load_dwordx4 v15, s[44:47], s29 offen offset:3072 lds
  v_mfma_f32_16x16x32_bf16 v[80:83], v[140:143], v[200:203], v[80:83]
  s_mov_b64 exec, 1
  ds_add_u32 v10, v11 offset:32
  s_mov_b64 exec, -1
  v_mfma_f32_16x16x32_bf16 v[84:87], v[40:43], v[204:207], v[84:87]
  s_waitcnt vmcnt(7)
  ds_read_b128 v[172:175], v30 offset:0
  v_mfma_f32_16x16x32_bf16 v[88:91], v[40:43], v[208:211], v[88:91]
  v_mfma_f32_16x16x32_bf16 v[252:255], v[40:43], v[144:147], v[252:255]
  ds_read_b64_tr_b16 v[40:41], v27 offset:28672
  v_mfma_f32_16x16x32_bf16 v[92:95], v[44:47], v[204:207], v[92:95]
  ds_read_b64_tr_b16 v[42:43], v27 offset:30464
  ds_read_b128 v[176:179], v30 offset:512
  v_mfma_f32_16x16x32_bf16 v[96:99], v[44:47], v[208:211], v[96:99]
  v_mfma_f32_16x16x32_bf16 v[252:255], v[44:47], v[148:151], v[252:255]
  ds_read_b64_tr_b16 v[44:45], v27 offset:28704
  v_mfma_f32_16x16x32_bf16 v[100:103], v[48:51], v[204:207], v[100:103]
  ds_read_b64_tr_b16 v[46:47], v27 offset:30496
  ds_read_b128 v[180:183], v31 offset:0
  v_mfma_f32_16x16x32_bf16 v[104:107], v[48:51], v[208:211], v[104:107]
  v_mfma_f32_16x16x32_bf16 v[252:255], v[48:51], v[152:155], v[252:255]
  ds_read_b64_tr_b16 v[48:49], v27 offset:28736
  s_waitcnt lgkmcnt(13)
  v_mfma_f32_16x16x32_bf16 v[108:111], v[52:55], v[204:207], v[108:111]
  ds_read_b64_tr_b16 v[50:51], v27 offset:30528
  ds_read_b128 v[184:187], v31 offset:512
  v_mfma_f32_16x16x32_bf16 v[112:115], v[52:55], v[208:211], v[112:115]
  v_mfma_f32_16x16x32_bf16 v[252:255], v[52:55], v[156:159], v[252:255]
  ds_read_b64_tr_b16 v[52:53], v27 offset:28768
  v_mfma_f32_16x16x32_bf16 v[116:119], v[56:59], v[204:207], v[116:119]
  ds_read_b64_tr_b16 v[54:55], v27 offset:30560
  s_waitcnt lgkmcnt(2)
  s_add_u32 m0, s86, 0
  s_xor_b32 s29, s85, 768
  buffer_load_dwordx4 v12, s[44:47], s29 offen offset:0 lds
  v_mfma_f32_16x16x32_bf16 v[120:123], v[56:59], v[208:211], v[120:123]
  v_mfma_f32_16x16x32_bf16 v[252:255], v[56:59], v[160:163], v[252:255]
  ds_read_b64_tr_b16 v[56:57], v27 offset:28800
  v_mfma_f32_16x16x32_bf16 v[124:127], v[60:63], v[204:207], v[124:127]
  ds_read_b64_tr_b16 v[58:59], v27 offset:30592
  buffer_load_dwordx4 v13, s[44:47], s29 offen offset:1024 lds
  v_mfma_f32_16x16x32_bf16 v[128:131], v[60:63], v[208:211], v[128:131]
  v_mfma_f32_16x16x32_bf16 v[252:255], v[60:63], v[164:167], v[252:255]
  ds_read_b64_tr_b16 v[60:61], v27 offset:28832
  v_mfma_f32_16x16x32_bf16 v[132:135], v[64:67], v[204:207], v[132:135]
  ds_read_b64_tr_b16 v[62:63], v27 offset:30624
  buffer_load_dwordx4 v14, s[44:47], s29 offen offset:2048 lds
  v_mfma_f32_16x16x32_bf16 v[136:139], v[64:67], v[208:211], v[136:139]
  v_mfma_f32_16x16x32_bf16 v[252:255], v[64:67], v[168:171], v[252:255]
  ds_read_b64_tr_b16 v[64:65], v27 offset:28864
  v_mfma_f32_16x16x32_bf16 v[68:71], v[204:207], v[204:207], v[68:71]
  ds_read_b64_tr_b16 v[66:67], v27 offset:30656
  buffer_load_dwordx4 v15, s[44:47], s29 offen offset:3072 lds
  v_mfma_f32_16x16x32_bf16 v[72:75], v[208:211], v[208:211], v[72:75]
  v_mfma_f32_16x16x32_bf16 v[76:79], v[140:143], v[204:207], v[76:79]
  v_mfma_f32_16x16x32_bf16 v[80:83], v[140:143], v[208:211], v[80:83]
  v_mfma_f32_16x16x32_bf16 v[84:87], v[40:43], v[212:215], v[84:87]
  s_waitcnt vmcnt(4)
  ds_read_b128 v[188:191], v30 offset:4096
  v_mfma_f32_16x16x32_bf16 v[88:91], v[40:43], v[216:219], v[88:91]
  ds_read_b64_tr_b16 v[40:41], v28 offset:28672
  v_mfma_f32_16x16x32_bf16 v[92:95], v[44:47], v[212:215], v[92:95]
  ds_read_b64_tr_b16 v[42:43], v28 offset:30464
  ds_read_b128 v[192:195], v30 offset:4608
  v_mfma_f32_16x16x32_bf16 v[96:99], v[44:47], v[216:219], v[96:99]
  ds_read_b64_tr_b16 v[44:45], v28 offset:28704
  v_mfma_f32_16x16x32_bf16 v[100:103], v[48:51], v[212:215], v[100:103]
  ds_read_b64_tr_b16 v[46:47], v28 offset:30496
  ds_read_b128 v[196:199], v31 offset:4096
  v_mfma_f32_16x16x32_bf16 v[104:107], v[48:51], v[216:219], v[104:107]
  ds_read_b64_tr_b16 v[48:49], v28 offset:28736
  s_waitcnt lgkmcnt(12)
  v_mfma_f32_16x16x32_bf16 v[108:111], v[52:55], v[212:215], v[108:111]
  ds_read_b64_tr_b16 v[50:51], v28 offset:30528
  ds_read_b128 v[200:203], v31 offset:4608
  v_mfma_f32_16x16x32_bf16 v[112:115], v[52:55], v[216:219], v[112:115]
  ds_read_b64_tr_b16 v[52:53], v28 offset:28768
  v_mfma_f32_16x16x32_bf16 v[116:119], v[56:59], v[212:215], v[116:119]
  ds_read_b64_tr_b16 v[54:55], v28 offset:30560
  v_mfma_f32_16x16x32_bf16 v[120:123], v[56:59], v[216:219], v[120:123]
  ds_read_b64_tr_b16 v[56:57], v28 offset:28800
  s_waitcnt lgkmcnt(3)
  s_add_u32 m0, s86, 4096
  s_xor_b32 s29, s85, 896
  buffer_load_dwordx4 v12, s[44:47], s29 offen offset:0 lds
  v_mfma_f32_16x16x32_bf16 v[124:127], v[60:63], v[212:215], v[124:127]
  ds_read_b64_tr_b16 v[58:59], v28 offset:30592
  v_mfma_f32_16x16x32_bf16 v[128:131], v[60:63], v[216:219], v[128:131]
  ds_read_b64_tr_b16 v[60:61], v28 offset:28832
  buffer_load_dwordx4 v13, s[44:47], s29 offen offset:1024 lds
  v_mfma_f32_16x16x32_bf16 v[132:135], v[64:67], v[212:215], v[132:135]
  ds_read_b64_tr_b16 v[62:63], v28 offset:30624
  v_mfma_f32_16x16x32_bf16 v[136:139], v[64:67], v[216:219], v[136:139]
  ds_read_b64_tr_b16 v[64:65], v28 offset:28864
  buffer_load_dwordx4 v14, s[44:47], s29 offen offset:2048 lds
  v_mfma_f32_16x16x32_bf16 v[68:71], v[212:215], v[212:215], v[68:71]
  ds_read_b64_tr_b16 v[66:67], v28 offset:30656
  v_mfma_f32_16x16x32_bf16 v[72:75], v[216:219], v[216:219], v[72:75]
  buffer_load_dwordx4 v15, s[44:47], s29 offen offset:3072 lds
  v_mfma_f32_16x16x32_bf16 v[76:79], v[140:143], v[212:215], v[76:79]
  v_mfma_f32_16x16x32_bf16 v[80:83], v[140:143], v[216:219], v[80:83]
  v_mfma_f32_16x16x32_bf16 v[84:87], v[40:43], v[220:223], v[84:87]
  s_mov_b64 exec, 1
  ds_add_u32 v10, v11 offset:8
  s_mov_b64 exec, -1
  v_mfma_f32_16x16x32_bf16 v[88:91], v[40:43], v[224:227], v[88:91]
  ds_read_b64_tr_b16 v[40:41], v29 offset:28672
  v_mfma_f32_16x16x32_bf16 v[92:95], v[44:47], v[220:223], v[92:95]
  ds_read_b64_tr_b16 v[42:43], v29 offset:30464
  v_mfma_f32_16x16x32_bf16 v[96:99], v[44:47], v[224:227], v[96:99]
  ds_read_b64_tr_b16 v[44:45], v29 offset:28704
  v_mfma_f32_16x16x32_bf16 v[100:103], v[48:51], v[220:223], v[100:103]
  ds_read_b64_tr_b16 v[46:47], v29 offset:30496
  v_mfma_f32_16x16x32_bf16 v[104:107], v[48:51], v[224:227], v[104:107]
  ds_read_b64_tr_b16 v[48:49], v29 offset:28736
  s_waitcnt lgkmcnt(10)
  v_mfma_f32_16x16x32_bf16 v[108:111], v[52:55], v[220:223], v[108:111]
  ds_read_b64_tr_b16 v[50:51], v29 offset:30528
  v_mfma_f32_16x16x32_bf16 v[112:115], v[52:55], v[224:227], v[112:115]
  ds_read_b64_tr_b16 v[52:53], v29 offset:28768
  v_mfma_f32_16x16x32_bf16 v[116:119], v[56:59], v[220:223], v[116:119]
  ds_read_b64_tr_b16 v[54:55], v29 offset:30560
  v_mfma_f32_16x16x32_bf16 v[120:123], v[56:59], v[224:227], v[120:123]
  ds_read_b64_tr_b16 v[56:57], v29 offset:28800
  s_waitcnt lgkmcnt(10)
  v_mfma_f32_16x16x32_bf16 v[124:127], v[60:63], v[220:223], v[124:127]
  ds_read_b64_tr_b16 v[58:59], v29 offset:30592
  v_mfma_f32_16x16x32_bf16 v[128:131], v[60:63], v[224:227], v[128:131]
  ds_read_b64_tr_b16 v[60:61], v29 offset:28832
  v_mfma_f32_16x16x32_bf16 v[132:135], v[64:67], v[220:223], v[132:135]
  ds_read_b64_tr_b16 v[62:63], v29 offset:30624
  v_mfma_f32_16x16x32_bf16 v[136:139], v[64:67], v[224:227], v[136:139]
  ds_read_b64_tr_b16 v[64:65], v29 offset:28864
  v_mfma_f32_16x16x32_bf16 v[68:71], v[220:223], v[220:223], v[68:71]
  ds_read_b64_tr_b16 v[66:67], v29 offset:30656
  v_mfma_f32_16x16x32_bf16 v[72:75], v[224:227], v[224:227], v[72:75]
  v_mfma_f32_16x16x32_bf16 v[76:79], v[140:143], v[220:223], v[76:79]
  v_mfma_f32_16x16x32_bf16 v[80:83], v[140:143], v[224:227], v[80:83]
Lc3:
  ds_read_b32 v8, v10 offset:8
  s_waitcnt lgkmcnt(0)
  v_cmp_gt_u32 vcc, 4, v8
  s_cbranch_vccz Lc3_x
  s_sub_u32 s30, s30, 1
  s_cmp_gt_i32 s30, 0
  s_cbranch_scc1 Lc3
Lc3_x:
  v_mfma_f32_16x16x32_bf16 v[84:87], v[40:43], v[228:231], v[84:87]
  v_mfma_f32_16x16x32_bf16 v[88:91], v[40:43], v[232:235], v[88:91]
  ds_read_b64_tr_b16 v[40:41], v26 offset:57344
  v_mfma_f32_16x16x32_bf16 v[92:95], v[44:47], v[228:231], v[92:95]
  ds_read_b64_tr_b16 v[42:43], v26 offset:59136
  v_mfma_f32_16x16x32_bf16 v[96:99], v[44:47], v[232:235], v[96:99]
  ds_read_b64_tr_b16 v[44:45], v26 offset:57376
  v_mfma_f32_16x16x32_bf16 v[100:103], v[48:51], v[228:231], v[100:103]
  ds_read_b64_tr_b16 v[46:47], v26 offset:59168
  v_mfma_f32_16x16x32_bf16 v[104:107], v[48:51], v[232:235], v[104:107]
  ds_read_b64_tr_b16 v[48:49], v26 offset:57408
  v_mfma_f32_16x16x32_bf16 v[108:111], v[52:55], v[228:231], v[108:111]
  ds_read_b64_tr_b16 v[50:51], v26 offset:59200
  v_mfma_f32_16x16x32_bf16 v[112:115], v[52:55], v[232:235], v[112:115]
  ds_read_b64_tr_b16 v[52:53], v26 offset:57440
  v_mfma_f32_16x16x32_bf16 v[116:119], v[56:59], v[228:231], v[116:119]
  ds_read_b64_tr_b16 v[54:55], v26 offset:59232
  v_mfma_f32_16x16x32_bf16 v[120:123], v[56:59], v[232:235], v[120:123]
  ds_read_b64_tr_b16 v[56:57], v26 offset:57472
  v_mfma_f32_16x16x32_bf16 v[124:127], v[60:63], v[228:231], v[124:127]
  ds_read_b64_tr_b16 v[58:59], v26 offset:59264
  v_mfma_f32_16x16x32_bf16 v[128:131], v[60:63], v[232:235], v[128:131]
  ds_read_b64_tr_b16 v[60:61], v26 offset:57504
  v_mfma_f32_16x16x32_bf16 v[132:135], v[64:67], v[228:231], v[132:135]
  ds_read_b64_tr_b16 v[62:63], v26 offset:59296
  v_mfma_f32_16x16x32_bf16 v[136:139], v[64:67], v[232:235], v[136:139]
  ds_read_b64_tr_b16 v[64:65], v26 offset:57536
  v_mfma_f32_16x16x32_bf16 v[68:71], v[228:231], v[228:231], v[68:71]
  ds_read_b64_tr_b16 v[66:67], v26 offset:59328
  v_mfma_f32_16x16x32_bf16 v[72:75], v[232:235], v[232:235], v[72:75]
  v_mfma_f32_16x16x32_bf16 v[76:79], v[140:143], v[228:231], v[76:79]
  v_mfma_f32_16x16x32_bf16 v[80:83], v[140:143], v[232:235], v[80:83]
  s_mov_b64 exec, 1
  ds_add_u32 v10, v11 offset:40
  s_mov_b64 exec, -1
  s_waitcnt lgkmcnt(9)
  v_mfma_f32_16x16x32_bf16 v[84:87], v[40:43], v[172:175], v[84:87]
  global_load_dwordx2 v[16:17], v9, s[40:41] sc1
  v_mfma_f32_16x16x32_bf16 v[88:91], v[40:43], v[176:179], v[88:91]
  v_mfma_f32_16x16x32_bf16 v[252:255], v[40:43], v[144:147], v[252:255]
  ds_read_b64_tr_b16 v[40:41], v27 offset:57344
  v_mfma_f32_16x16x32_bf16 v[92:95], v[44:47], v[172:175], v[92:95]
  ds_read_b64_tr_b16 v[42:43], v27 offset:59136
  v_mfma_f32_16x16x32_bf16 v[96:99], v[44:47], v[176:179], v[96:99]
  v_mfma_f32_16x16x32_bf16 v[252:255], v[44:47], v[148:151], v[252:255]
  ds_read_b64_tr_b16 v[44:45], v27 offset:57376
  v_mfma_f32_16x16x32_bf16 v[100:103], v[48:51], v[172:175], v[100:103]
  ds_read_b64_tr_b16 v[46:47], v27 offset:59168
  v_mfma_f32_16x16x32_bf16 v[104:107], v[48:51], v[176:179], v[104:107]
  v_mfma_f32_16x16x32_bf16 v[252:255], v[48:51], v[152:155], v[252:255]
  ds_read_b64_tr_b16 v[48:49], v27 offset:57408
  s_waitcnt lgkmcnt(10)
  v_mfma_f32_16x16x32_bf16 v[108:111], v[52:55], v[172:175], v[108:111]
  ds_read_b64_tr_b16 v[50:51], v27 offset:59200
  v_mfma_f32_16x16x32_bf16 v[112:115], v[52:55], v[176:179], v[112:115]
  v_mfma_f32_16x16x32_bf16 v[252:255], v[52:55], v[156:159], v[252:255]
  ds_read_b64_tr_b16 v[52:53], v27 offset:57440
  v_mfma_f32_16x16x32_bf16 v[116:119], v[56:59], v[172:175], v[116:119]
  ds_read_b64_tr_b16 v[54:55], v27 offset:59232
  global_load_dwordx2 v[36:37], v236, s[32:33]
  v_mfma_f32_16x16x32_bf16 v[120:123], v[56:59], v[176:179], v[120:123]
  v_mfma_f32_16x16x32_bf16 v[252:255], v[56:59], v[160:163], v[252:255]
  ds_read_b64_tr_b16 v[56:57], v27 offset:57472
  s_waitcnt lgkmcnt(10)
  v_mfma_f32_16x16x32_bf16 v[124:127], v[60:63], v[172:175], v[124:127]
  ds_read_b64_tr_b16 v[58:59], v27 offset:59264
  v_mfma_f32_16x16x32_bf16 v[128:131], v[60:63], v[176:179], v[128:131]
  v_mfma_f32_16x16x32_bf16 v[252:255], v[60:63], v[164:167], v[252:255]
  ds_read_b64_tr_b16 v[60:61], v27 offset:57504
  v_mfma_f32_16x16x32_bf16 v[132:135], v[64:67], v[172:175], v[132:135]
  ds_read_b64_tr_b16 v[62:63], v27 offset:59296
  v_mfma_f32_16x16x32_bf16 v[136:139], v[64:67], v[176:179], v[136:139]
  v_mfma_f32_16x16x32_bf16 v[252:255], v[64:67], v[168:171], v[252:255]
  ds_read_b64_tr_b16 v[64:65], v27 offset:57536
  v_mfma_f32_16x16x32_bf16 v[68:71], v[172:175], v[172:175], v[68:71]
  ds_read_b64_tr_b16 v[66:67], v27 offset:59328
  v_mfma_f32_16x16x32_bf16 v[72:75], v[176:179], v[176:179], v[72:75]
  v_mfma_f32_16x16x32_bf16 v[76:79], v[140:143], v[172:175], v[76:79]
  v_mfma_f32_16x16x32_bf16 v[80:83], v[140:143], v[176:179], v[80:83]
  s_waitcnt lgkmcnt(8)
  v_mfma_f32_16x16x32_bf16 v[84:87], v[40:43], v[180:183], v[84:87]
  s_waitcnt vmcnt(6)
  ds_read_b128 v[204:207], v30 offset:0
  v_mfma_f32_16x16x32_bf16 v[88:91], v[40:43], v[184:187], v[88:91]
  ds_read_b64_tr_b16 v[40:41], v28 offset:57344
  v_mfma_f32_16x16x32_bf16 v[92:95], v[44:47], v[180:183], v[92:95]
  ds_read_b64_tr_b16 v[42:43], v28 offset:59136
  v_mfma_f32_16x16x32_bf16 v[96:99], v[44:47], v[184:187], v[96:99]
  ds_read_b64_tr_b16 v[44:45], v28 offset:57376
  v_mfma_f32_16x16x32_bf16 v[100:103], v[48:51], v[180:183], v[100:103]
  ds_read_b64_tr_b16 v[46:47], v28 offset:59168
  ds_read_b128 v[208:211], v30 offset:512
  v_mfma_f32_16x16x32_bf16 v[104:107], v[48:51], v[184:187], v[104:107]
  ds_read_b64_tr_b16 v[48:49], v28 offset:57408
  s_waitcnt lgkmcnt(11)
  v_mfma_f32_16x16x32_bf16 v[108:111], v[52:55], v[180:183], v[108:111]
  ds_read_b64_tr_b16 v[50:51], v28 offset:59200
  v_mfma_f32_16x16x32_bf16 v[112:115], v[52:55], v[184:187], v[112:115]
  ds_read_b64_tr_b16 v[52:53], v28 offset:57440
  v_mfma_f32_16x16x32_bf16 v[116:119], v[56:59], v[180:183], v[116:119]
  ds_read_b64_tr_b16 v[54:55], v28 offset:59232
  v_mfma_f32_16x16x32_bf16 v[120:123], v[56:59], v[184:187], v[120:123]
  ds_read_b64_tr_b16 v[56:57], v28 offset:57472
  ds_read_b128 v[212:215], v31 offset:0
  s_waitcnt lgkmcnt(12)
  v_mfma_f32_16x16x32_bf16 v[124:127], v[60:63], v[180:183], v[124:127]
  ds_read_b64_tr_b16 v[58:59], v28 offset:59264
  v_mfma_f32_16x16x32_bf16 v[128:131], v[60:63], v[184:187], v[128:131]
  ds_read_b64_tr_b16 v[60:61], v28 offset:57504
  v_mfma_f32_16x16x32_bf16 v[132:135], v[64:67], v[180:183], v[132:135]
  ds_read_b64_tr_b16 v[62:63], v28 offset:59296
  v_mfma_f32_16x16x32_bf16 v[136:139], v[64:67], v[184:187], v[136:139]
  ds_read_b64_tr_b16 v[64:65], v28 offset:57536
  ds_read_b128 v[216:219], v31 offset:512
  v_mfma_f32_16x16x32_bf16 v[68:71], v[180:183], v[180:183], v[68:71]
  ds_read_b64_tr_b16 v[66:67], v28 offset:59328
  v_mfma_f32_16x16x32_bf16 v[72:75], v[184:187], v[184:187], v[72:75]
  v_mfma_f32_16x16x32_bf16 v[76:79], v[140:143], v[180:183], v[76:79]
  v_mfma_f32_16x16x32_bf16 v[80:83], v[140:143], v[184:187], v[80:83]
  s_waitcnt lgkmcnt(10)
  v_mfma_f32_16x16x32_bf16 v[84:87], v[40:43], v[188:191], v[84:87]
  s_waitcnt vmcnt(2)
  ds_read_b128 v[220:223], v30 offset:4096
  v_mfma_f32_16x16x32_bf16 v[88:91], v[40:43], v[192:195], v[88:91]
  ds_read_b64_tr_b16 v[40:41], v29 offset:57344
  v_mfma_f32_16x16x32_bf16 v[92:95], v[44:47], v[188:191], v[92:95]
  ds_read_b64_tr_b16 v[42:43], v29 offset:59136
  v_mfma_f32_16x16x32_bf16 v[96:99], v[44:47], v[192:195], v[96:99]
  ds_read_b64_tr_b16 v[44:45], v29 offset:57376
  v_mfma_f32_16x16x32_bf16 v[100:103], v[48:51], v[188:191], v[100:103]
  ds_read_b64_tr_b16 v[46:47], v29 offset:59168
  ds_read_b128 v[224:227], v30 offset:4608
  v_mfma_f32_16x16x32_bf16 v[104:107], v[48:51], v[192:195], v[104:107]
  ds_read_b64_tr_b16 v[48:49], v29 offset:57408
  s_waitcnt lgkmcnt(12)
  v_mfma_f32_16x16x32_bf16 v[108:111], v[52:55], v[188:191], v[108:111]
  ds_read_b64_tr_b16 v[50:51], v29 offset:59200
  v_mfma_f32_16x16x32_bf16 v[112:115], v[52:55], v[192:195], v[112:115]
  ds_read_b64_tr_b16 v[52:53], v29 offset:57440
  v_mfma_f32_16x16x32_bf16 v[116:119], v[56:59], v[188:191], v[116:119]
  ds_read_b64_tr_b16 v[54:55], v29 offset:59232
  v_mfma_f32_16x16x32_bf16 v[120:123], v[56:59], v[192:195], v[120:123]
  ds_read_b64_tr_b16 v[56:57], v29 offset:57472
  ds_read_b128 v[228:231], v31 offset:4096
  s_waitcnt lgkmcnt(12)
  v_mfma_f32_16x16x32_bf16 v[124:127], v[60:63], v[188:191], v[124:127]
  ds_read_b64_tr_b16 v[58:59], v29 offset:59264
  v_mfma_f32_16x16x32_bf16 v[128:131], v[60:63], v[192:195], v[128:131]
  ds_read_b64_tr_b16 v[60:61], v29 offset:57504
  v_mfma_f32_16x16x32_bf16 v[132:135], v[64:67], v[188:191], v[132:135]
  ds_read_b64_tr_b16 v[62:63], v29 offset:59296
  v_mfma_f32_16x16x32_bf16 v[136:139], v[64:67], v[192:195], v[136:139]
  ds_read_b64_tr_b16 v[64:65], v29 offset:57536
  ds_read_b128 v[232:235], v31 offset:4608
  v_mfma_f32_16x16x32_bf16 v[68:71], v[188:191], v[188:191], v[68:71]
  ds_read_b64_tr_b16 v[66:67], v29 offset:59328
  v_mfma_f32_16x16x32_bf16 v[72:75], v[192:195], v[192:195], v[72:75]
  v_mfma_f32_16x16x32_bf16 v[76:79], v[140:143], v[188:191], v[76:79]
  v_mfma_f32_16x16x32_bf16 v[80:83], v[140:143], v[192:195], v[80:83]
Lc4:
  ds_read_b32 v8, v10 offset:12
  s_waitcnt lgkmcnt(0)
  v_cmp_gt_u32 vcc, 4, v8
  s_cbranch_vccz Lc4_x
  s_sub_u32 s30, s30, 1
  s_cmp_gt_i32 s30, 0
  s_cbranch_scc1 Lc4
Lc4_x:
  v_mfma_f32_16x16x32_bf16 v[84:87], v[40:43], v[196:199], v[84:87]
  s_mov_b64 exec, 1
  ds_add_u32 v10, v11 offset:16
  s_mov_b64 exec, -1
  v_mfma_f32_16x16x32_bf16 v[88:91], v[40:43], v[200:203], v[88:91]
  ds_read_b64_tr_b16 v[40:41], v26 offset:0
  v_mfma_f32_16x16x32_bf16 v[92:95], v[44:47], v[196:199], v[92:95]
  ds_read_b64_tr_b16 v[42:43], v26 offset:1792
  v_mfma_f32_16x16x32_bf16 v[96:99], v[44:47], v[200:203], v[96:99]
  ds_read_b64_tr_b16 v[44:45], v26 offset:32
  v_mfma_f32_16x16x32_bf16 v[100:103], v[48:51], v[196:199], v[100:103]
  ds_read_b64_tr_b16 v[46:47], v26 offset:1824
  v_mfma_f32_16x16x32_bf16 v[104:107], v[48:51], v[200:203], v[104:107]
  ds_read_b64_tr_b16 v[48:49], v26 offset:64
  v_mfma_f32_16x16x32_bf16 v[108:111], v[52:55], v[196:199], v[108:111]
  ds_read_b64_tr_b16 v[50:51], v26 offset:1856
  v_mfma_f32_16x16x32_bf16 v[112:115], v[52:55], v[200:203], v[112:115]
  ds_read_b64_tr_b16 v[52:53], v26 offset:96
  v_mfma_f32_16x16x32_bf16 v[116:119], v[56:59], v[196:199], v[116:119]
  ds_read_b64_tr_b16 v[54:55], v26 offset:1888
  v_mfma_f32_16x16x32_bf16 v[120:123], v[56:59], v[200:203], v[120:123]
  ds_read_b64_tr_b16 v[56:57], v26 offset:128
  v_mfma_f32_16x16x32_bf16 v[124:127], v[60:63], v[196:199], v[124:127]
  ds_read_b64_tr_b16 v[58:59], v26 offset:1920
  v_mfma_f32_16x16x32_bf16 v[128:131], v[60:63], v[200:203], v[128:131]
  ds_read_b64_tr_b16 v[60:61], v26 offset:160
  v_mfma_f32_16x16x32_bf16 v[132:135], v[64:67], v[196:199], v[132:135]
  ds_read_b64_tr_b16 v[62:63], v26 offset:1952
  v_mfma_f32_16x16x32_bf16 v[136:139], v[64:67], v[200:203], v[136:139]
  ds_read_b64_tr_b16 v[64:65], v26 offset:192
  v_mfma_f32_16x16x32_bf16 v[68:71], v[196:199], v[196:199], v[68:71]
  ds_read_b64_tr_b16 v[66:67], v26 offset:1984
  v_mfma_f32_16x16x32_bf16 v[72:75], v[200:203], v[200:203], v[72:75]
  v_mfma_f32_16x16x32_bf16 v[76:79], v[140:143], v[196:199], v[76:79]
  v_mfma_f32_16x16x32_bf16 v[80:83], v[140:143], v[200:203], v[80:83]
  s_waitcnt lgkmcnt(8)
  v_mfma_f32_16x16x32_bf16 v[84:87], v[40:43], v[204:207], v[84:87]
  s_waitcnt vmcnt(0)
  v_mfma_f32_16x16x32_bf16 v[88:91], v[40:43], v[208:211], v[88:91]
  v_mfma_f32_16x16x32_bf16 v[252:255], v[40:43], v[144:147], v[252:255]
  ds_read_b64_tr_b16 v[40:41], v27 offset:0
  v_mfma_f32_16x16x32_bf16 v[92:95], v[44:47], v[204:207], v[92:95]
  ds_read_b64_tr_b16 v[42:43], v27 offset:1792
  v_mfma_f32_16x16x32_bf16 v[96:99], v[44:47], v[208:211], v[96:99]
  v_lshlrev_b32 v236, 16, v36
  v_mfma_f32_16x16x32_bf16 v[252:255], v[44:47], v[148:151], v[252:255]
  ds_read_b64_tr_b16 v[44:45], v27 offset:32
  v_mfma_f32_16x16x32_bf16 v[100:103], v[48:51], v[204:207], v[100:103]
  ds_read_b64_tr_b16 v[46:47], v27 offset:1824
  v_mfma_f32_16x16x32_bf16 v[104:107], v[48:51], v[208:211], v[104:107]
  v_mfma_f32_16x16x32_bf16 v[252:255], v[48:51], v[152:155], v[252:255]
  ds_read_b64_tr_b16 v[48:49], v27 offset:64
  v_and_b32 v237, s15, v36
  s_waitcnt lgkmcnt(9)
  v_mfma_f32_16x16x32_bf16 v[108:111], v[52:55], v[204:207], v[108:111]
  ds_read_b64_tr_b16 v[50:51], v27 offset:1856
  v_mfma_f32_16x16x32_bf16 v[112:115], v[52:55], v[208:211], v[112:115]
  v_mfma_f32_16x16x32_bf16 v[252:255], v[52:55], v[156:159], v[252:255]
  ds_read_b64_tr_b16 v[52:53], v27 offset:96
  v_mfma_f32_16x16x32_bf16 v[116:119], v[56:59], v[204:207], v[116:119]
  ds_read_b64_tr_b16 v[54:55], v27 offset:1888
  v_lshlrev_b32 v238, 16, v37
  v_mfma_f32_16x16x32_bf16 v[120:123], v[56:59], v[208:211], v[120:123]
  v_mfma_f32_16x16x32_bf16 v[252:255], v[56:59], v[160:163], v[252:255]
  ds_read_b64_tr_b16 v[56:57], v27 offset:128
  s_waitcnt lgkmcnt(9)
  v_mfma_f32_16x16x32_bf16 v[124:127], v[60:63], v[204:207], v[124:127]
  ds_read_b64_tr_b16 v[58:59], v27 offset:1920
  v_mfma_f32_16x16x32_bf16 v[128:131], v[60:63], v[208:211], v[128:131]
  v_and_b32 v239, s15, v37
  v_mfma_f32_16x16x32_bf16 v[252:255], v[60:63], v[164:167], v[252:255]
  ds_read_b64_tr_b16 v[60:61], v27 offset:160
  v_mfma_f32_16x16x32_bf16 v[132:135], v[64:67], v[204:207], v[132:135]
  ds_read_b64_tr_b16 v[62:63], v27 offset:1952
  v_mfma_f32_16x16x32_bf16 v[136:139], v[64:67], v[208:211], v[136:139]
  v_mfma_f32_16x16x32_bf16 v[252:255], v[64:67], v[168:171], v[252:255]
  ds_read_b64_tr_b16 v[64:65], v27 offset:192
  s_mov_b64 exec, 0xfffffff
  ds_write_b128 v34, v[236:239] offset:2048
  s_mov_b64 exec, -1
  v_mfma_f32_16x16x32_bf16 v[68:71], v[204:207], v[204:207], v[68:71]
  ds_read_b64_tr_b16 v[66:67], v27 offset:1984
  v_mfma_f32_16x16x32_bf16 v[72:75], v[208:211], v[208:211], v[72:75]
  v_mfma_f32_16x16x32_bf16 v[76:79], v[140:143], v[204:207], v[76:79]
  v_mfma_f32_16x16x32_bf16 v[80:83], v[140:143], v[208:211], v[80:83]
  s_waitcnt lgkmcnt(9)
  v_mfma_f32_16x16x32_bf16 v[84:87], v[40:43], v[212:215], v[84:87]
  v_and_b32 v36, 15, v1
  v_lshl_add_u32 v36, v36, 6, v33
  s_mov_b32 exec_lo, 0x7f007f
  s_mov_b32 exec_hi, 0x7f007f
  ds_write_b128 v36, v[252:255]
  s_mov_b64 exec, 1
  ds_add_u32 v10, v11 offset:72
  s_mov_b64 exec, -1
  v_mfma_f32_16x16x32_bf16 v[88:91], v[40:43], v[216:219], v[88:91]
  ds_read_b64_tr_b16 v[40:41], v28 offset:0
  v_mfma_f32_16x16x32_bf16 v[92:95], v[44:47], v[212:215], v[92:95]
  ds_read_b64_tr_b16 v[42:43], v28 offset:1792
  v_mfma_f32_16x16x32_bf16 v[96:99], v[44:47], v[216:219], v[96:99]
  ds_read_b64_tr_b16 v[44:45], v28 offset:32
  v_mfma_f32_16x16x32_bf16 v[100:103], v[48:51], v[212:215], v[100:103]
  ds_read_b64_tr_b16 v[46:47], v28 offset:1824
  v_mfma_f32_16x16x32_bf16 v[104:107], v[48:51], v[216:219], v[104:107]
  ds_read_b64_tr_b16 v[48:49], v28 offset:64
  s_waitcnt lgkmcnt(12)
  v_mfma_f32_16x16x32_bf16 v[108:111], v[52:55], v[212:215], v[108:111]
  ds_read_b64_tr_b16 v[50:51], v28 offset:1856
  v_mfma_f32_16x16x32_bf16 v[112:115], v[52:55], v[216:219], v[112:115]
  ds_read_b64_tr_b16 v[52:53], v28 offset:96
  v_mfma_f32_16x16x32_bf16 v[116:119], v[56:59], v[212:215], v[116:119]
  ds_read_b64_tr_b16 v[54:55], v28 offset:1888
  v_mfma_f32_16x16x32_bf16 v[120:123], v[56:59], v[216:219], v[120:123]
  ds_read_b64_tr_b16 v[56:57], v28 offset:128
  s_waitcnt lgkmcnt(11)
  v_mfma_f32_16x16x32_bf16 v[124:127], v[60:63], v[212:215], v[124:127]
  ds_read_b64_tr_b16 v[58:59], v28 offset:1920
  v_mfma_f32_16x16x32_bf16 v[128:131], v[60:63], v[216:219], v[128:131]
  ds_read_b64_tr_b16 v[60:61], v28 offset:160
  v_mfma_f32_16x16x32_bf16 v[132:135], v[64:67], v[212:215], v[132:135]
  ds_read_b64_tr_b16 v[62:63], v28 offset:1952
  v_mfma_f32_16x16x32_bf16 v[136:139], v[64:67], v[216:219], v[136:139]
  ds_read_b64_tr_b16 v[64:65], v28 offset:192
  v_mfma_f32_16x16x32_bf16 v[68:71], v[212:215], v[212:215], v[68:71]
  ds_read_b64_tr_b16 v[66:67], v28 offset:1984
  v_mfma_f32_16x16x32_bf16 v[72:75], v[216:219], v[216:219], v[72:75]
  v_mfma_f32_16x16x32_bf16 v[76:79], v[140:143], v[212:215], v[76:79]
  v_mfma_f32_16x16x32_bf16 v[80:83], v[140:143], v[216:219], v[80:83]
Lc5:
  ds_read_b32 v8, v10 offset:72
  s_waitcnt lgkmcnt(0)
  v_cmp_gt_u32 vcc, 4, v8
  s_cbranch_vccz Lc5_x
  s_sub_u32 s30, s30, 1
  s_cmp_gt_i32 s30, 0
  s_cbranch_scc1 Lc5
Lc5_x:
  v_mfma_f32_16x16x32_bf16 v[84:87], v[40:43], v[220:223], v[84:87]
  s_add_u32 m0, s82, 86016
  s_lshl_b32 s100, s14, 16
  s_cmp_eq_u32 s14, 7
  s_cselect_b32 s100, 0x8000, s100
  s_add_u32 s84, s100, s83
  buffer_load_dwordx4 v12, s[72:75], s84 offen offset:0 lds
  ds_read_b128 v[236:239], v34 offset:0
  v_mfma_f32_16x16x32_bf16 v[88:91], v[40:43], v[224:227], v[88:91]
  ds_read_b64_tr_b16 v[40:41], v29 offset:0
  ds_read_b128 v[240:243], v34 offset:512
  v_mfma_f32_16x16x32_bf16 v[92:95], v[44:47], v[220:223], v[92:95]
  ds_read_b64_tr_b16 v[42:43], v29 offset:1792
  ds_read_b128 v[244:247], v34 offset:1024
  v_mfma_f32_16x16x32_bf16 v[96:99], v[44:47], v[224:227], v[96:99]
  ds_read_b64_tr_b16 v[44:45], v29 offset:32
  ds_read_b128 v[248:251], v34 offset:1536
  v_mfma_f32_16x16x32_bf16 v[100:103], v[48:51], v[220:223], v[100:103]
  ds_read_b64_tr_b16 v[46:47], v29 offset:1824
  buffer_load_dwordx4 v13, s[72:75], s84 offen offset:1024 lds
  v_mfma_f32_16x16x32_bf16 v[104:107], v[48:51], v[224:227], v[104:107]
  ds_read_b64_tr_b16 v[48:49], v29 offset:64
  ds_read_b128 v[144:147], v32 offset:2048
  v_mfma_f32_16x16x32_bf16 v[108:111], v[52:55], v[220:223], v[108:111]
  ds_read_b64_tr_b16 v[50:51], v29 offset:1856
  ds_read_b128 v[148:151], v32 offset:2112
  v_mfma_f32_16x16x32_bf16 v[112:115], v[52:55], v[224:227], v[112:115]
  ds_read_b64_tr_b16 v[52:53], v29 offset:96
  ds_read_b128 v[152:155], v32 offset:2176
  v_mfma_f32_16x16x32_bf16 v[116:119], v[56:59], v[220:223], v[116:119]
  ds_read_b64_tr_b16 v[54:55], v29 offset:1888
  v_mfma_f32_16x16x32_bf16 v[120:123], v[56:59], v[224:227], v[120:123]
  ds_read_b64_tr_b16 v[56:57], v29 offset:128
  buffer_load_dwordx4 v14, s[72:75], s84 offen offset:2048 lds
  ds_read_b128 v[156:159], v32 offset:2240
  v_mfma_f32_16x16x32_bf16 v[124:127], v[60:63], v[220:223], v[124:127]
  ds_read_b64_tr_b16 v[58:59], v29 offset:1920
  ds_read_b128 v[160:163], v32 offset:2304
  v_mfma_f32_16x16x32_bf16 v[128:131], v[60:63], v[224:227], v[128:131]
  ds_read_b64_tr_b16 v[60:61], v29 offset:160
  ds_read_b128 v[164:167], v32 offset:2368
  v_mfma_f32_16x16x32_bf16 v[132:135], v[64:67], v[220:223], v[132:135]
  ds_read_b64_tr_b16 v[62:63], v29 offset:1952
  ds_read_b128 v[168:171], v32 offset:2432
  v_mfma_f32_16x16x32_bf16 v[136:139], v[64:67], v[224:227], v[136:139]
  ds_read_b64_tr_b16 v[64:65], v29 offset:192
  buffer_load_dwordx4 v15, s[72:75], s84 offen offset:3072 lds
  v_mfma_f32_16x16x32_bf16 v[68:71], v[220:223], v[220:223], v[68:71]
  ds_read_b64_tr_b16 v[66:67], v29 offset:1984
  s_waitcnt lgkmcnt(15)
  v_mfma_f32_16x16x32_bf16 v[72:75], v[224:227], v[224:227], v[72:75]
  v_add_f32 v236, v236, v240
  v_mfma_f32_16x16x32_bf16 v[76:79], v[140:143], v[220:223], v[76:79]
  v_add_f32 v237, v237, v241
  v_mfma_f32_16x16x32_bf16 v[80:83], v[140:143], v[224:227], v[80:83]
  v_mfma_f32_16x16x32_bf16 v[68:71], v[228:231], v[228:231], v[68:71]
  s_add_u32 m0, s82, 102400
  s_add_u32 s100, s100, 0x8000
  s_cmp_eq_u32 s100, 458752
  s_cselect_b32 s100, 0, s100
  s_add_u32 s84, s100, s83
  buffer_load_dwordx4 v12, s[72:75], s84 offen offset:0 lds
  v_add_f32 v238, v238, v242
  v_add_f32 v239, v239, v243
  v_mfma_f32_16x16x32_bf16 v[72:75], v[232:235], v[232:235], v[72:75]
  v_add_f32 v244, v244, v248
  v_mfma_f32_16x16x32_bf16 v[76:79], v[140:143], v[228:231], v[76:79]
  v_add_f32 v245, v245, v249
  v_mfma_f32_16x16x32_bf16 v[80:83], v[140:143], v[232:235], v[80:83]
  v_add_f32 v246, v246, v250
  s_waitcnt lgkmcnt(14)
  v_mfma_f32_16x16x32_bf16 v[84:87], v[40:43], v[228:231], v[84:87]
  buffer_load_dwordx4 v13, s[72:75], s84 offen offset:1024 lds
  v_add_f32 v247, v247, v251
  v_mfma_f32_16x16x32_bf16 v[88:91], v[40:43], v[232:235], v[88:91]
  v_add_f32 v236, v236, v244
  v_mfma_f32_16x16x32_bf16 v[92:95], v[44:47], v[228:231], v[92:95]
  v_add_f32 v237, v237, v245
  v_mfma_f32_16x16x32_bf16 v[96:99], v[44:47], v[232:235], v[96:99]
  v_add_f32 v238, v238, v246
  v_mfma_f32_16x16x32_bf16 v[100:103], v[48:51], v[228:231], v[100:103]
  v_add_f32 v239, v239, v247
  v_mfma_f32_16x16x32_bf16 v[104:107], v[48:51], v[232:235], v[104:107]
  buffer_load_dwordx4 v14, s[72:75], s84 offen offset:2048 lds
  v_add_u32 v34, s97, v34
  s_waitcnt lgkmcnt(7)
  v_mfma_f32_16x16x32_bf16 v[108:111], v[52:55], v[228:231], v[108:111]
  s_mov_b64 exec, 0xfffffff
  ds_write_b128 v34, v[236:239] offset:2560
  s_mov_b64 exec, -1
  v_mfma_f32_16x16x32_bf16 v[112:115], v[52:55], v[232:235], v[112:115]
  ds_read_b128 v[172:175], v33 offset:2560
  v_mfma_f32_16x16x32_bf16 v[116:119], v[56:59], v[228:231], v[116:119]
  ds_read_b128 v[176:179], v33 offset:2624
  v_mfma_f32_16x16x32_bf16 v[120:123], v[56:59], v[232:235], v[120:123]
  buffer_load_dwordx4 v15, s[72:75], s84 offen offset:3072 lds
  ds_read_b128 v[180:183], v33 offset:2688
  s_waitcnt lgkmcnt(4)
  v_mfma_f32_16x16x32_bf16 v[124:127], v[60:63], v[228:231], v[124:127]
  ds_read_b128 v[184:187], v33 offset:2752
  v_mfma_f32_16x16x32_bf16 v[128:131], v[60:63], v[232:235], v[128:131]
  ds_read_b128 v[188:191], v33 offset:2816
  v_mfma_f32_16x16x32_bf16 v[132:135], v[64:67], v[228:231], v[132:135]
  ds_read_b128 v[192:195], v33 offset:2880
  v_mfma_f32_16x16x32_bf16 v[136:139], v[64:67], v[232:235], v[136:139]
  ds_read_b128 v[196:199], v33 offset:2944
  s_mov_b64 exec, 1
  ds_add_u32 v10, v11 offset:36
  s_mov_b64 exec, -1
  s_mov_b32 s88, 0x22222222
  s_mov_b32 s89, 0x22222222
  s_mov_b32 s90, 0x44444444
  s_mov_b32 s91, 0x44444444
  s_mov_b32 s92, 0x88888888
  s_mov_b32 s93, 0x88888888
  s_mov_b32 s94, 0xf0000f
  s_mov_b32 s95, 0xf0000f00
  s_waitcnt lgkmcnt(1)
  v_cndmask_b32 v68, v68, v69, s[88:89]
  v_cndmask_b32 v68, v68, v70, s[90:91]
  v_cndmask_b32 v68, v68, v71, s[92:93]
  v_cndmask_b32 v26, 0, v68, s[94:95]
  v_mov_b32 v68, v26
  v_cndmask_b32 v72, v72, v73, s[88:89]
  v_cndmask_b32 v72, v72, v74, s[90:91]
  v_cndmask_b32 v72, v72, v75, s[92:93]
  v_cndmask_b32 v27, 0, v72, s[94:95]
  v_mov_b32 v72, v27
  s_mov_b32 s3, 0x3b000000
  s_mov_b32 s4, 0x3727c5ac
  v_permlane32_swap_b32 v68, v26
  v_permlane32_swap_b32 v72, v27
  v_mul_f32 v28, s3, v76
  v_mul_f32 v29, s3, v80
  v_add_f32 v26, v26, v68
  v_add_f32 v27, v27, v72
  v_mov_b32 v68, v26
  v_mov_b32 v72, v27
  v_mov_b32 v248, 0xc0135761
  v_mov_b32 v249, 0xc0135761
  v_mov_b32 v140, 1.0
  v_mov_b32 v141, 1.0
  v_permlane16_swap_b32 v68, v26
  v_permlane16_swap_b32 v72, v27
  v_lshlrev_b32 v250, 4, v1
  v_add_f32 v26, v26, v68
  v_add_f32 v27, v27, v72
  v_mul_f32 v30, s3, v26
  v_mul_f32 v31, s3, v27
  v_fma_f32 v30, -v28, v28, v30
  v_fma_f32 v31, -v29, v29, v31
  v_max_f32 v30, 0, v30
  v_max_f32 v31, 0, v31
  v_cvt_pk_bf16_f32 v6, v30, v31
  v_lshlrev_b32 v34, 16, v6
  v_and_b32 v35, s15, v6
  v_add_f32 v34, s4, v34
  v_add_f32 v35, s4, v35
  v_cvt_pk_bf16_f32 v6, v34, v35
  v_lshlrev_b32 v34, 16, v6
  v_and_b32 v35, s15, v6
  v_sqrt_f32 v34, v34
  v_sqrt_f32 v35, v35
  s_mov_b32 s92, 0xbdd2d3e8
  v_cvt_pk_bf16_f32 v6, v34, v35
  v_lshlrev_b32 v34, 16, v6
  v_and_b32 v35, s15, v6
  v_rcp_f32 v38, v34
  v_rcp_f32 v39, v35
  s_mov_b32 s93, 0xbdd2d3e8
  v_mul_f32 v36, v30, v38
  v_mul_f32 v37, v31, v39
  v_mul_f32 v36, v36, v38
  v_mul_f32 v37, v37, v39
  v_cvt_pk_bf16_f32 v6, v36, v37
  v_lshlrev_b32 v36, 16, v6
  v_and_b32 v37, s15, v6
  v_add_f32 v36, s4, v36
  v_add_f32 v37, s4, v37
  v_cvt_pk_bf16_f32 v6, v36, v37
  v_lshlrev_b32 v36, 16, v6
  v_and_b32 v37, s15, v6
  v_sqrt_f32 v36, v36
  v_sqrt_f32 v37, v37
  s_and_b32 s94, s12, 1
  v_cvt_pk_bf16_f32 v6, v36, v37
  v_lshlrev_b32 v36, 16, v6
  v_and_b32 v37, s15, v6
  v_rcp_f32 v36, v36
  v_rcp_f32 v37, v37
  s_lshr_b32 s3, s7, 4
  s_mul_i32 s3, s3, 57344
  s_add_u32 s3, s3, 0x200000
  s_mul_i32 s4, s12, 7
  s_lshr_b32 s4, s4, 1
  s_lshl_b32 s4, s4, 10
  s_add_u32 s88, s3, s4
  s_add_u32 s89, s88, 57344
  v_mul_f32 v240, v36, v38
  v_mul_f32 v241, v36, v38
  v_mul_f32 v244, v37, v39
  v_mul_f32 v245, v37, v39
  v_mul_f32 v242, -v240, v28
  v_mul_f32 v243, -v240, v28
  v_mul_f32 v246, -v244, v29
  v_mul_f32 v247, -v244, v29
  s_cmp_lg_u32 s12, 0
  s_cbranch_scc1 L_nostat
  v_cvt_pk_bf16_f32 v6, v28, v29
  v_lshlrev_b32 v32, 16, v6
  v_and_b32 v33, s15, v6
  v_add_u32 v3, s7, v1
  v_lshlrev_b32 v3, 3, v3
  s_mov_b32 s3, 0xb00000
  v_mov_b32 v40, v32
  v_mov_b32 v41, v38
  v_mov_b32 v42, v33
  v_mov_b32 v43, v39
  s_mov_b64 exec, 0xffff
  buffer_store_dwordx2 v[40:41], v3, s[52:55], s3 offen offset:0 sc1
  buffer_store_dwordx2 v[42:43], v3, s[52:55], s3 offen offset:128 sc1
  s_mov_b64 exec, -1
  s_nop 1
L_nostat:
  v_mov_b32 v251, 0xbdd2d3e8
  s_lshl_b32 s28, s11, 10
  s_lshl_b32 s3, s12, 5
  s_add_u32 s28, s28, s3
  s_lshl_b32 s3, s8, 3
  s_add_u32 s28, s28, s3
  s_add_u32 s28, s28, 0xd00000
  v_cmp_eq_u32 vcc, 0, v17
  s_cbranch_vccz Lc6_x
  s_mov_b32 s4, 0
Lc6:
  global_load_dwordx2 v[16:17], v9, s[40:41] sc1
  s_add_u32 s4, s4, 1
  s_waitcnt vmcnt(0)
  v_cmp_eq_u32 vcc, 0, v17
  s_cmp_ge_u32 s4, 30000
  s_cbranch_scc1 Lc6_x
  s_cbranch_vccnz Lc6
Lc6_x:
  v_pk_fma_f32 v[72:73], v[172:173], v[242:243], v[144:145]
  v_pk_fma_f32 v[74:75], v[174:175], v[242:243], v[146:147]
  v_pk_fma_f32 v[84:85], v[84:85], v[240:241], v[72:73]
  v_pk_fma_f32 v[86:87], v[86:87], v[240:241], v[74:75]
  v_pk_mul_f32 v[72:73], v[84:85], v[84:85]
  v_pk_mul_f32 v[74:75], v[86:87], v[86:87]
  v_pk_fma_f32 v[72:73], v[72:73], s[92:93], v[248:249]
  v_pk_fma_f32 v[74:75], v[74:75], s[92:93], v[248:249]
  v_pk_mul_f32 v[72:73], v[72:73], v[84:85]
  v_pk_mul_f32 v[74:75], v[74:75], v[86:87]
  v_exp_f32 v72, v72
  v_exp_f32 v74, v74
  v_exp_f32 v73, v73
  v_exp_f32 v75, v75
  v_pk_add_f32 v[72:73], v[72:73], v[140:141]
  v_pk_add_f32 v[74:75], v[74:75], v[140:141]
  v_rcp_f32 v72, v72
  v_rcp_f32 v74, v74
  v_rcp_f32 v73, v73
  v_rcp_f32 v75, v75
  v_pk_mul_f32 v[72:73], v[72:73], v[84:85]
  v_pk_mul_f32 v[74:75], v[74:75], v[86:87]
  v_cvt_pk_bf16_f32 v42, v72, v73
  v_cvt_pk_bf16_f32 v43, v74, v75
  s_add_u32 m0, s82, 49152
  s_add_u32 s100, s100, 0x8000
  s_cmp_eq_u32 s100, 458752
  s_cselect_b32 s100, 0, s100
  s_add_u32 s84, s100, s83
  buffer_load_dwordx4 v12, s[72:75], s84 offen offset:0 lds
  buffer_load_dwordx4 v13, s[72:75], s84 offen offset:1024 lds
  buffer_load_dwordx4 v14, s[72:75], s84 offen offset:2048 lds
  buffer_load_dwordx4 v15, s[72:75], s84 offen offset:3072 lds
  v_pk_fma_f32 v[76:77], v[176:177], v[242:243], v[148:149]
  v_pk_fma_f32 v[78:79], v[178:179], v[242:243], v[150:151]
  v_pk_fma_f32 v[92:93], v[92:93], v[240:241], v[76:77]
  v_pk_fma_f32 v[94:95], v[94:95], v[240:241], v[78:79]
  v_pk_mul_f32 v[76:77], v[92:93], v[92:93]
  v_pk_mul_f32 v[78:79], v[94:95], v[94:95]
  v_pk_fma_f32 v[76:77], v[76:77], s[92:93], v[248:249]
  v_pk_fma_f32 v[78:79], v[78:79], s[92:93], v[248:249]
  v_pk_mul_f32 v[76:77], v[76:77], v[92:93]
  v_pk_mul_f32 v[78:79], v[78:79], v[94:95]
  v_exp_f32 v76, v76
  v_exp_f32 v78, v78
  v_exp_f32 v77, v77
  v_exp_f32 v79, v79
  v_pk_add_f32 v[76:77], v[76:77], v[140:141]
  v_pk_add_f32 v[78:79], v[78:79], v[140:141]
  v_rcp_f32 v76, v76
  v_rcp_f32 v78, v78
  v_rcp_f32 v77, v77
  v_rcp_f32 v79, v79
  v_pk_mul_f32 v[76:77], v[76:77], v[92:93]
  v_pk_mul_f32 v[78:79], v[78:79], v[94:95]
  v_cvt_pk_bf16_f32 v44, v76, v77
  v_cvt_pk_bf16_f32 v45, v78, v79
  s_add_u32 m0, s82, 65536
  s_add_u32 s100, s100, 0x8000
  s_cmp_eq_u32 s100, 458752
  s_cselect_b32 s100, 0, s100
  s_add_u32 s84, s100, s83
  buffer_load_dwordx4 v12, s[72:75], s84 offen offset:0 lds
  buffer_load_dwordx4 v13, s[72:75], s84 offen offset:1024 lds
  buffer_load_dwordx4 v14, s[72:75], s84 offen offset:2048 lds
  buffer_load_dwordx4 v15, s[72:75], s84 offen offset:3072 lds
  v_pk_fma_f32 v[72:73], v[180:181], v[242:243], v[152:153]
  v_pk_fma_f32 v[74:75], v[182:183], v[242:243], v[154:155]
  v_pk_fma_f32 v[100:101], v[100:101], v[240:241], v[72:73]
  v_pk_fma_f32 v[102:103], v[102:103], v[240:241], v[74:75]
  v_pk_mul_f32 v[72:73], v[100:101], v[100:101]
  v_pk_mul_f32 v[74:75], v[102:103], v[102:103]
  v_pk_fma_f32 v[72:73], v[72:73], s[92:93], v[248:249]
  v_pk_fma_f32 v[74:75], v[74:75], s[92:93], v[248:249]
  v_pk_mul_f32 v[72:73], v[72:73], v[100:101]
  v_pk_mul_f32 v[74:75], v[74:75], v[102:103]
  v_exp_f32 v72, v72
  v_exp_f32 v74, v74
  v_exp_f32 v73, v73
  v_exp_f32 v75, v75
  v_pk_add_f32 v[72:73], v[72:73], v[140:141]
  v_pk_add_f32 v[74:75], v[74:75], v[140:141]
  v_rcp_f32 v72, v72
  v_rcp_f32 v74, v74
  v_rcp_f32 v73, v73
  v_rcp_f32 v75, v75
  v_pk_mul_f32 v[72:73], v[72:73], v[100:101]
  v_pk_mul_f32 v[74:75], v[74:75], v[102:103]
  v_cvt_pk_bf16_f32 v46, v72, v73
  v_cvt_pk_bf16_f32 v47, v74, v75
Lc7:
  ds_read_b32 v8, v10 offset:36
  s_waitcnt lgkmcnt(0)
  v_cmp_gt_u32 vcc, 4, v8
  s_cbranch_vccz Lc7_x
  s_sub_u32 s30, s30, 1
  s_cmp_gt_i32 s30, 0
  s_cbranch_scc1 Lc7
Lc7_x:
  s_add_u32 m0, s82, 0
  s_add_u32 s100, s100, 0x8000
  s_cmp_eq_u32 s100, 458752
  s_cselect_b32 s100, 0, s100
  s_add_u32 s84, s100, s83
  buffer_load_dwordx4 v12, s[72:75], s84 offen offset:0 lds
  buffer_load_dwordx4 v13, s[72:75], s84 offen offset:1024 lds
  buffer_load_dwordx4 v14, s[72:75], s84 offen offset:2048 lds
  buffer_load_dwordx4 v15, s[72:75], s84 offen offset:3072 lds
  v_pk_fma_f32 v[76:77], v[184:185], v[242:243], v[156:157]
  v_pk_fma_f32 v[78:79], v[186:187], v[242:243], v[158:159]
  v_pk_fma_f32 v[108:109], v[108:109], v[240:241], v[76:77]
  v_pk_fma_f32 v[110:111], v[110:111], v[240:241], v[78:79]
  v_pk_mul_f32 v[76:77], v[108:109], v[108:109]
  v_pk_mul_f32 v[78:79], v[110:111], v[110:111]
  v_pk_fma_f32 v[76:77], v[76:77], s[92:93], v[248:249]
  v_pk_fma_f32 v[78:79], v[78:79], s[92:93], v[248:249]
  v_pk_mul_f32 v[76:77], v[76:77], v[108:109]
  v_pk_mul_f32 v[78:79], v[78:79], v[110:111]
  v_exp_f32 v76, v76
  v_exp_f32 v78, v78
  v_exp_f32 v77, v77
  v_exp_f32 v79, v79
  v_pk_add_f32 v[76:77], v[76:77], v[140:141]
  v_pk_add_f32 v[78:79], v[78:79], v[140:141]
  v_rcp_f32 v76, v76
  v_rcp_f32 v78, v78
  v_rcp_f32 v77, v77
  v_rcp_f32 v79, v79
  v_pk_mul_f32 v[76:77], v[76:77], v[108:109]
  v_pk_mul_f32 v[78:79], v[78:79], v[110:111]
  v_cvt_pk_bf16_f32 v48, v76, v77
  v_cvt_pk_bf16_f32 v49, v78, v79
  v_pk_fma_f32 v[72:73], v[188:189], v[242:243], v[160:161]
  v_pk_fma_f32 v[74:75], v[190:191], v[242:243], v[162:163]
  v_pk_fma_f32 v[116:117], v[116:117], v[240:241], v[72:73]
  v_pk_fma_f32 v[118:119], v[118:119], v[240:241], v[74:75]
  v_pk_mul_f32 v[72:73], v[116:117], v[116:117]
  v_pk_mul_f32 v[74:75], v[118:119], v[118:119]
  v_pk_fma_f32 v[72:73], v[72:73], s[92:93], v[248:249]
  v_pk_fma_f32 v[74:75], v[74:75], s[92:93], v[248:249]
  v_pk_mul_f32 v[72:73], v[72:73], v[116:117]
  v_pk_mul_f32 v[74:75], v[74:75], v[118:119]
  v_exp_f32 v72, v72
  v_exp_f32 v74, v74
  v_exp_f32 v73, v73
  v_exp_f32 v75, v75
  v_pk_add_f32 v[72:73], v[72:73], v[140:141]
  v_pk_add_f32 v[74:75], v[74:75], v[140:141]
  v_rcp_f32 v72, v72
  v_rcp_f32 v74, v74
  v_rcp_f32 v73, v73
  v_rcp_f32 v75, v75
  v_pk_mul_f32 v[72:73], v[72:73], v[116:117]
  v_pk_mul_f32 v[74:75], v[74:75], v[118:119]
  v_cvt_pk_bf16_f32 v50, v72, v73
  v_cvt_pk_bf16_f32 v51, v74, v75
  v_pk_fma_f32 v[76:77], v[192:193], v[242:243], v[164:165]
  v_pk_fma_f32 v[78:79], v[194:195], v[242:243], v[166:167]
  v_pk_fma_f32 v[124:125], v[124:125], v[240:241], v[76:77]
  v_pk_fma_f32 v[126:127], v[126:127], v[240:241], v[78:79]
  v_pk_mul_f32 v[76:77], v[124:125], v[124:125]
  v_pk_mul_f32 v[78:79], v[126:127], v[126:127]
  v_pk_fma_f32 v[76:77], v[76:77], s[92:93], v[248:249]
  v_pk_fma_f32 v[78:79], v[78:79], s[92:93], v[248:249]
  v_pk_mul_f32 v[76:77], v[76:77], v[124:125]
  v_pk_mul_f32 v[78:79], v[78:79], v[126:127]
  v_exp_f32 v76, v76
  v_exp_f32 v78, v78
  v_exp_f32 v77, v77
  v_exp_f32 v79, v79
  v_pk_add_f32 v[76:77], v[76:77], v[140:141]
  v_pk_add_f32 v[78:79], v[78:79], v[140:141]
  v_rcp_f32 v76, v76
  v_rcp_f32 v78, v78
  v_rcp_f32 v77, v77
  v_rcp_f32 v79, v79
  v_pk_mul_f32 v[76:77], v[76:77], v[124:125]
  v_pk_mul_f32 v[78:79], v[78:79], v[126:127]
  v_cvt_pk_bf16_f32 v52, v76, v77
  v_cvt_pk_bf16_f32 v53, v78, v79
  v_pk_fma_f32 v[72:73], v[196:197], v[242:243], v[168:169]
  v_pk_fma_f32 v[74:75], v[198:199], v[242:243], v[170:171]
  v_pk_fma_f32 v[132:133], v[132:133], v[240:241], v[72:73]
  v_pk_fma_f32 v[134:135], v[134:135], v[240:241], v[74:75]
  v_pk_mul_f32 v[72:73], v[132:133], v[132:133]
  v_pk_mul_f32 v[74:75], v[134:135], v[134:135]
  v_pk_fma_f32 v[72:73], v[72:73], s[92:93], v[248:249]
  v_pk_fma_f32 v[74:75], v[74:75], s[92:93], v[248:249]
  v_pk_mul_f32 v[72:73], v[72:73], v[132:133]
  v_pk_mul_f32 v[74:75], v[74:75], v[134:135]
  v_exp_f32 v72, v72
  v_exp_f32 v74, v74
  v_exp_f32 v73, v73
  v_exp_f32 v75, v75
  v_pk_add_f32 v[72:73], v[72:73], v[140:141]
  v_pk_add_f32 v[74:75], v[74:75], v[140:141]
  v_rcp_f32 v72, v72
  v_rcp_f32 v74, v74
  v_rcp_f32 v73, v73
  v_rcp_f32 v75, v75
  v_pk_mul_f32 v[72:73], v[72:73], v[132:133]
  v_pk_mul_f32 v[74:75], v[74:75], v[134:135]
  v_cvt_pk_bf16_f32 v54, v72, v73
  v_cvt_pk_bf16_f32 v55, v74, v75
  s_mov_b64 exec, 1
  ds_add_u32 v10, v11 offset:96
  s_mov_b64 exec, -1
  s_cmp_lg_u32 s94, 0
  s_cbranch_scc1 L_hs0_odd
  buffer_store_dwordx4 v[42:45], v250, s[52:55], s88 offen offset:0 sc1
  buffer_store_dwordx4 v[46:49], v250, s[52:55], s88 offen offset:1024 sc1
  buffer_store_dwordx4 v[50:53], v250, s[52:55], s88 offen offset:2048 sc1
  buffer_store_dwordx2 v[54:55], v250, s[52:55], s88 offen offset:3072 sc1
  s_branch L_hs0_e
L_hs0_odd:
  buffer_store_dwordx2 v[42:43], v250, s[52:55], s88 offen offset:8 sc1
  buffer_store_dwordx4 v[44:47], v250, s[52:55], s88 offen offset:1024 sc1
  buffer_store_dwordx4 v[48:51], v250, s[52:55], s88 offen offset:2048 sc1
  buffer_store_dwordx4 v[52:55], v250, s[52:55], s88 offen offset:3072 sc1
L_hs0_e:
  v_fmac_f32 v144, v172, v246
  v_fmac_f32 v146, v174, v246
  v_fmac_f32 v145, v173, v246
  v_fmac_f32 v147, v175, v246
  v_fmac_f32 v144, v88, v244
  v_fmac_f32 v146, v90, v244
  v_fmac_f32 v145, v89, v244
  v_fmac_f32 v147, v91, v244
  v_mul_f32 v72, v144, v144
  v_mul_f32 v74, v146, v146
  v_mul_f32 v73, v145, v145
  v_mul_f32 v75, v147, v147
  v_fma_f32 v72, v72, v251, v248
  v_fma_f32 v74, v74, v251, v248
  v_fma_f32 v73, v73, v251, v248
  v_fma_f32 v75, v75, v251, v248
  v_mul_f32 v72, v72, v144
  v_mul_f32 v74, v74, v146
  v_mul_f32 v73, v73, v145
  v_mul_f32 v75, v75, v147
  v_exp_f32 v72, v72
  v_exp_f32 v74, v74
  v_exp_f32 v73, v73
  v_exp_f32 v75, v75
  v_add_f32 v72, 1.0, v72
  v_add_f32 v74, 1.0, v74
  v_add_f32 v73, 1.0, v73
  v_add_f32 v75, 1.0, v75
  v_rcp_f32 v72, v72
  v_rcp_f32 v74, v74
  v_rcp_f32 v73, v73
  v_rcp_f32 v75, v75
  v_mul_f32 v72, v72, v144
  v_mul_f32 v74, v74, v146
  v_mul_f32 v73, v73, v145
  v_mul_f32 v75, v75, v147
  v_cvt_pk_bf16_f32 v58, v72, v73
  v_cvt_pk_bf16_f32 v59, v74, v75
  v_fmac_f32 v148, v176, v246
  v_fmac_f32 v150, v178, v246
  v_fmac_f32 v149, v177, v246
  v_fmac_f32 v151, v179, v246
  v_fmac_f32 v148, v96, v244
  v_fmac_f32 v150, v98, v244
  v_fmac_f32 v149, v97, v244
  v_fmac_f32 v151, v99, v244
  v_mul_f32 v76, v148, v148
  v_mul_f32 v78, v150, v150
  v_mul_f32 v77, v149, v149
  v_mul_f32 v79, v151, v151
  v_fma_f32 v76, v76, v251, v248
  v_fma_f32 v78, v78, v251, v248
  v_fma_f32 v77, v77, v251, v248
  v_fma_f32 v79, v79, v251, v248
  v_mul_f32 v76, v76, v148
  v_mul_f32 v78, v78, v150
  v_mul_f32 v77, v77, v149
  v_mul_f32 v79, v79, v151
  v_exp_f32 v76, v76
  v_exp_f32 v78, v78
  v_exp_f32 v77, v77
  v_exp_f32 v79, v79
  v_add_f32 v76, 1.0, v76
  v_add_f32 v78, 1.0, v78
  v_add_f32 v77, 1.0, v77
  v_add_f32 v79, 1.0, v79
  v_rcp_f32 v76, v76
  v_rcp_f32 v78, v78
  v_rcp_f32 v77, v77
  v_rcp_f32 v79, v79
  v_mul_f32 v76, v76, v148
  v_mul_f32 v78, v78, v150
  v_mul_f32 v77, v77, v149
  v_mul_f32 v79, v79, v151
  v_cvt_pk_bf16_f32 v60, v76, v77
  v_cvt_pk_bf16_f32 v61, v78, v79
  v_fmac_f32 v152, v180, v246
  v_fmac_f32 v154, v182, v246
  v_fmac_f32 v153, v181, v246
  v_fmac_f32 v155, v183, v246
  v_fmac_f32 v152, v104, v244
  v_fmac_f32 v154, v106, v244
  v_fmac_f32 v153, v105, v244
  v_fmac_f32 v155, v107, v244
  v_mul_f32 v72, v152, v152
  v_mul_f32 v74, v154, v154
  v_mul_f32 v73, v153, v153
  v_mul_f32 v75, v155, v155
  v_fma_f32 v72, v72, v251, v248
  v_fma_f32 v74, v74, v251, v248
  v_fma_f32 v73, v73, v251, v248
  v_fma_f32 v75, v75, v251, v248
  v_mul_f32 v72, v72, v152
  v_mul_f32 v74, v74, v154
  v_mul_f32 v73, v73, v153
  v_mul_f32 v75, v75, v155
  v_exp_f32 v72, v72
  v_exp_f32 v74, v74
  v_exp_f32 v73, v73
  v_exp_f32 v75, v75
  v_add_f32 v72, 1.0, v72
  v_add_f32 v74, 1.0, v74
  v_add_f32 v73, 1.0, v73
  v_add_f32 v75, 1.0, v75
  v_rcp_f32 v72, v72
  v_rcp_f32 v74, v74
  v_rcp_f32 v73, v73
  v_rcp_f32 v75, v75
  v_mul_f32 v72, v72, v152
  v_mul_f32 v74, v74, v154
  v_mul_f32 v73, v73, v153
  v_mul_f32 v75, v75, v155
  v_cvt_pk_bf16_f32 v62, v72, v73
  v_cvt_pk_bf16_f32 v63, v74, v75
  v_fmac_f32 v156, v184, v246
  v_fmac_f32 v158, v186, v246
  v_fmac_f32 v157, v185, v246
  v_fmac_f32 v159, v187, v246
  v_fmac_f32 v156, v112, v244
  v_fmac_f32 v158, v114, v244
  v_fmac_f32 v157, v113, v244
  v_fmac_f32 v159, v115, v244
  v_mul_f32 v76, v156, v156
  v_mul_f32 v78, v158, v158
  v_mul_f32 v77, v157, v157
  v_mul_f32 v79, v159, v159
  v_fma_f32 v76, v76, v251, v248
  v_fma_f32 v78, v78, v251, v248
  v_fma_f32 v77, v77, v251, v248
  v_fma_f32 v79, v79, v251, v248
  v_mul_f32 v76, v76, v156
  v_mul_f32 v78, v78, v158
  v_mul_f32 v77, v77, v157
  v_mul_f32 v79, v79, v159
  v_exp_f32 v76, v76
  v_exp_f32 v78, v78
  v_exp_f32 v77, v77
  v_exp_f32 v79, v79
  v_add_f32 v76, 1.0, v76
  v_add_f32 v78, 1.0, v78
  v_add_f32 v77, 1.0, v77
  v_add_f32 v79, 1.0, v79
  v_rcp_f32 v76, v76
  v_rcp_f32 v78, v78
  v_rcp_f32 v77, v77
  v_rcp_f32 v79, v79
  v_mul_f32 v76, v76, v156
  v_mul_f32 v78, v78, v158
  v_mul_f32 v77, v77, v157
  v_mul_f32 v79, v79, v159
  v_cvt_pk_bf16_f32 v64, v76, v77
  v_cvt_pk_bf16_f32 v65, v78, v79
  s_waitcnt vmcnt(0)
  s_mov_b64 exec, 1
  buffer_store_dwordx2 v[16:17], v9, s[52:55], s28 offen sc1
  s_mov_b64 exec, -1
  s_add_u32 s28, s28, 512
  v_fmac_f32 v160, v188, v246
  v_fmac_f32 v162, v190, v246
  v_fmac_f32 v161, v189, v246
  v_fmac_f32 v163, v191, v246
  v_fmac_f32 v160, v120, v244
  v_fmac_f32 v162, v122, v244
  v_fmac_f32 v161, v121, v244
  v_fmac_f32 v163, v123, v244
  v_mul_f32 v72, v160, v160
  v_mul_f32 v74, v162, v162
  v_mul_f32 v73, v161, v161
  v_mul_f32 v75, v163, v163
  v_fma_f32 v72, v72, v251, v248
  v_fma_f32 v74, v74, v251, v248
  v_fma_f32 v73, v73, v251, v248
  v_fma_f32 v75, v75, v251, v248
  v_mul_f32 v72, v72, v160
  v_mul_f32 v74, v74, v162
  v_mul_f32 v73, v73, v161
  v_mul_f32 v75, v75, v163
  v_exp_f32 v72, v72
  v_exp_f32 v74, v74
  v_exp_f32 v73, v73
  v_exp_f32 v75, v75
  v_add_f32 v72, 1.0, v72
  v_add_f32 v74, 1.0, v74
  v_add_f32 v73, 1.0, v73
  v_add_f32 v75, 1.0, v75
  v_rcp_f32 v72, v72
  v_rcp_f32 v74, v74
  v_rcp_f32 v73, v73
  v_rcp_f32 v75, v75
  v_mul_f32 v72, v72, v160
  v_mul_f32 v74, v74, v162
  v_mul_f32 v73, v73, v161
  v_mul_f32 v75, v75, v163
  v_cvt_pk_bf16_f32 v66, v72, v73
  v_cvt_pk_bf16_f32 v67, v74, v75
  v_fmac_f32 v164, v192, v246
  v_fmac_f32 v166, v194, v246
  v_fmac_f32 v165, v193, v246
  v_fmac_f32 v167, v195, v246
  v_fmac_f32 v164, v128, v244
  v_fmac_f32 v166, v130, v244
  v_fmac_f32 v165, v129, v244
  v_fmac_f32 v167, v131, v244
  v_mul_f32 v76, v164, v164
  v_mul_f32 v78, v166, v166
  v_mul_f32 v77, v165, v165
  v_mul_f32 v79, v167, v167
  v_fma_f32 v76, v76, v251, v248
  v_fma_f32 v78, v78, v251, v248
  v_fma_f32 v77, v77, v251, v248
  v_fma_f32 v79, v79, v251, v248
  v_mul_f32 v76, v76, v164
  v_mul_f32 v78, v78, v166
  v_mul_f32 v77, v77, v165
  v_mul_f32 v79, v79, v167
  v_exp_f32 v76, v76
  v_exp_f32 v78, v78
  v_exp_f32 v77, v77
  v_exp_f32 v79, v79
  v_add_f32 v76, 1.0, v76
  v_add_f32 v78, 1.0, v78
  v_add_f32 v77, 1.0, v77
  v_add_f32 v79, 1.0, v79
  v_rcp_f32 v76, v76
  v_rcp_f32 v78, v78
  v_rcp_f32 v77, v77
  v_rcp_f32 v79, v79
  v_mul_f32 v76, v76, v164
  v_mul_f32 v78, v78, v166
  v_mul_f32 v77, v77, v165
  v_mul_f32 v79, v79, v167
  v_cvt_pk_bf16_f32 v68, v76, v77
  v_cvt_pk_bf16_f32 v69, v78, v79
  v_fmac_f32 v168, v196, v246
  v_fmac_f32 v170, v198, v246
  v_fmac_f32 v169, v197, v246
  v_fmac_f32 v171, v199, v246
  v_fmac_f32 v168, v136, v244
  v_fmac_f32 v170, v138, v244
  v_fmac_f32 v169, v137, v244
  v_fmac_f32 v171, v139, v244
  v_mul_f32 v72, v168, v168
  v_mul_f32 v74, v170, v170
  v_mul_f32 v73, v169, v169
  v_mul_f32 v75, v171, v171
  v_fma_f32 v72, v72, v251, v248
  v_fma_f32 v74, v74, v251, v248
  v_fma_f32 v73, v73, v251, v248
  v_fma_f32 v75, v75, v251, v248
  v_mul_f32 v72, v72, v168
  v_mul_f32 v74, v74, v170
  v_mul_f32 v73, v73, v169
  v_mul_f32 v75, v75, v171
  v_exp_f32 v72, v72
  v_exp_f32 v74, v74
  v_exp_f32 v73, v73
  v_exp_f32 v75, v75
  v_add_f32 v72, 1.0, v72
  v_add_f32 v74, 1.0, v74
  v_add_f32 v73, 1.0, v73
  v_add_f32 v75, 1.0, v75
  v_rcp_f32 v72, v72
  v_rcp_f32 v74, v74
  v_rcp_f32 v73, v73
  v_rcp_f32 v75, v75
  v_mul_f32 v72, v72, v168
  v_mul_f32 v74, v74, v170
  v_mul_f32 v73, v73, v169
  v_mul_f32 v75, v75, v171
  v_cvt_pk_bf16_f32 v70, v72, v73
  v_cvt_pk_bf16_f32 v71, v74, v75
  s_cmp_lg_u32 s94, 0
  s_cbranch_scc1 L_hs1_odd
  buffer_store_dwordx4 v[58:61], v250, s[52:55], s89 offen offset:0 sc1
  buffer_store_dwordx4 v[62:65], v250, s[52:55], s89 offen offset:1024 sc1
  buffer_store_dwordx4 v[66:69], v250, s[52:55], s89 offen offset:2048 sc1
  buffer_store_dwordx2 v[70:71], v250, s[52:55], s89 offen offset:3072 sc1
  s_branch L_hs1_e
L_hs1_odd:
  buffer_store_dwordx2 v[58:59], v250, s[52:55], s89 offen offset:8 sc1
  buffer_store_dwordx4 v[60:63], v250, s[52:55], s89 offen offset:1024 sc1
  buffer_store_dwordx4 v[64:67], v250, s[52:55], s89 offen offset:2048 sc1
  buffer_store_dwordx4 v[68:71], v250, s[52:55], s89 offen offset:3072 sc1
L_hs1_e:
  s_setprio 0
  v_bfe_u32 v2, v1, 1, 2
  s_lshl_b32 s3, s8, 2
  v_add_u32 v2, s3, v2
  v_and_b32 v3, 1, v1
  v_lshlrev_b32 v2, 5, v2
  v_lshl_add_u32 v26, v3, 3, v2
  s_lshr_b32 s3, s13, 1
  s_lshl_b32 s97, s3, 10
  s_and_b32 s3, s13, 1
  s_lshl_b32 s3, s3, 4
  s_add_u32 s97, s97, s3
  s_add_u32 s97, s97, 0xd00000
  s_mul_i32 s88, s13, 229376
  s_mul_i32 s3, s8, 14336
  s_add_u32 s88, s88, s3
  s_add_u32 s88, s88, 0x200000
  s_add_u32 s89, s88, 57344
  s_add_u32 s90, s89, 57344
  s_add_u32 s91, s90, 57344
  v_lshl_add_u32 v2, v1, 4, s88
  v_lshl_add_u32 v3, v1, 4, s89
  v_lshl_add_u32 v4, v1, 4, s90
  v_lshl_add_u32 v5, v1, 4, s91
  s_lshl_b32 s56, s14, 11
  s_cmp_eq_u32 s14, 7
  s_cselect_b32 s56, 0x400, s56
  s_add_u32 s57, s56, 0x400
  s_cmp_eq_u32 s57, 14336
  s_cselect_b32 s57, 0, s57
  s_add_u32 s58, s57, 0x400
  s_cmp_eq_u32 s58, 14336
  s_cselect_b32 s58, 0, s58
  s_add_u32 s59, s58, 0x400
  s_cmp_eq_u32 s59, 14336
  s_cselect_b32 s59, 0, s59
  s_add_u32 s60, s59, 0x400
  s_cmp_eq_u32 s60, 14336
  s_cselect_b32 s60, 0, s60
  s_add_u32 s61, s60, 0x400
  s_cmp_eq_u32 s61, 14336
  s_cselect_b32 s61, 0, s61
  s_add_u32 s62, s61, 0x400
  s_cmp_eq_u32 s62, 14336
  s_cselect_b32 s62, 0, s62
  s_add_u32 s63, s62, 0x400
  s_cmp_eq_u32 s63, 14336
  s_cselect_b32 s63, 0, s63
  s_add_u32 s64, s63, 0x400
  s_cmp_eq_u32 s64, 14336
  s_cselect_b32 s64, 0, s64
  s_add_u32 s65, s64, 0x400
  s_cmp_eq_u32 s65, 14336
  s_cselect_b32 s65, 0, s65
  s_add_u32 s66, s65, 0x400
  s_cmp_eq_u32 s66, 14336
  s_cselect_b32 s66, 0, s66
  s_add_u32 s67, s66, 0x400
  s_cmp_eq_u32 s67, 14336
  s_cselect_b32 s67, 0, s67
  s_add_u32 s68, s67, 0x400
  s_cmp_eq_u32 s68, 14336
  s_cselect_b32 s68, 0, s68
  s_add_u32 s69, s68, 0x400
  s_cmp_eq_u32 s69, 14336
  s_cselect_b32 s69, 0, s69
  s_lshl_b32 s4, s8, 10
  v_lshl_add_u32 v27, v1, 4, s4
  v_add_u32 v30, 126976, v27
  ds_read_b64_tr_b16 v[208:209], v22 offset:20480
  ds_read_b64_tr_b16 v[210:211], v22 offset:20992
  ds_read_b64_tr_b16 v[212:213], v23 offset:20480
  ds_read_b64_tr_b16 v[214:215], v23 offset:20992
  ds_read_b64_tr_b16 v[216:217], v24 offset:20480
  ds_read_b64_tr_b16 v[218:219], v24 offset:20992
  ds_read_b64_tr_b16 v[220:221], v25 offset:20480
  ds_read_b64_tr_b16 v[222:223], v25 offset:20992
  ds_read_b64_tr_b16 v[224:225], v22 offset:36864
  ds_read_b64_tr_b16 v[226:227], v22 offset:37376
  ds_read_b64_tr_b16 v[228:229], v23 offset:36864
  ds_read_b64_tr_b16 v[230:231], v23 offset:37376
  ds_read_b64_tr_b16 v[232:233], v24 offset:36864
  ds_read_b64_tr_b16 v[234:235], v24 offset:37376
  ds_read_b64_tr_b16 v[236:237], v25 offset:36864
  ds_read_b64_tr_b16 v[238:239], v25 offset:37376
  s_waitcnt lgkmcnt(8)
  s_add_u32 m0, s82, 86016
  s_add_u32 s100, s100, 0x8000
  s_cmp_eq_u32 s100, 458752
  s_cselect_b32 s100, 0, s100
  s_add_u32 s84, s100, s83
  buffer_load_dwordx4 v12, s[72:75], s84 offen offset:0 lds
  buffer_load_dwordx4 v13, s[72:75], s84 offen offset:1024 lds
  buffer_load_dwordx4 v14, s[72:75], s84 offen offset:2048 lds
  buffer_load_dwordx4 v15, s[72:75], s84 offen offset:3072 lds
  ds_read_b64_tr_b16 v[100:101], v18 offset:49152
  ds_read_b64_tr_b16 v[102:103], v18 offset:49664
  ds_read_b64_tr_b16 v[108:109], v19 offset:49152
  ds_read_b64_tr_b16 v[110:111], v19 offset:49664
  ds_read_b64_tr_b16 v[116:117], v20 offset:49152
  ds_read_b64_tr_b16 v[118:119], v20 offset:49664
  ds_read_b64_tr_b16 v[124:125], v21 offset:49152
  ds_read_b64_tr_b16 v[126:127], v21 offset:49664
  s_waitcnt lgkmcnt(8)
  s_add_u32 m0, s82, 102400
  s_add_u32 s100, s100, 0x8000
  s_cmp_eq_u32 s100, 458752
  s_cselect_b32 s100, 0, s100
  s_add_u32 s84, s100, s83
  buffer_load_dwordx4 v12, s[72:75], s84 offen offset:0 lds
  buffer_load_dwordx4 v13, s[72:75], s84 offen offset:1024 lds
  buffer_load_dwordx4 v14, s[72:75], s84 offen offset:2048 lds
  buffer_load_dwordx4 v15, s[72:75], s84 offen offset:3072 lds
  ds_read_b64_tr_b16 v[132:133], v22 offset:0
  ds_read_b64_tr_b16 v[134:135], v22 offset:512
  ds_read_b64_tr_b16 v[200:201], v23 offset:0
  ds_read_b64_tr_b16 v[202:203], v23 offset:512
  ds_read_b64_tr_b16 v[204:205], v24 offset:0
  ds_read_b64_tr_b16 v[206:207], v24 offset:512
  ds_read_b64_tr_b16 v[252:253], v25 offset:0
  ds_read_b64_tr_b16 v[254:255], v25 offset:512
  s_waitcnt lgkmcnt(8)
  s_add_u32 m0, s82, 49152
  s_add_u32 s100, s100, 0x8000
  s_cmp_eq_u32 s100, 458752
  s_cselect_b32 s100, 0, s100
  s_add_u32 s84, s100, s83
  buffer_load_dwordx4 v12, s[72:75], s84 offen offset:0 lds
  buffer_load_dwordx4 v13, s[72:75], s84 offen offset:1024 lds
  buffer_load_dwordx4 v14, s[72:75], s84 offen offset:2048 lds
  buffer_load_dwordx4 v15, s[72:75], s84 offen offset:3072 lds
  ds_read_b64_tr_b16 v[96:97], v18 offset:0
  ds_read_b64_tr_b16 v[98:99], v18 offset:512
  ds_read_b64_tr_b16 v[104:105], v19 offset:0
  ds_read_b64_tr_b16 v[106:107], v19 offset:512
  ds_read_b64_tr_b16 v[112:113], v20 offset:0
  ds_read_b64_tr_b16 v[114:115], v20 offset:512
  ds_read_b64_tr_b16 v[120:121], v21 offset:0
  ds_read_b64_tr_b16 v[122:123], v21 offset:512
  s_waitcnt lgkmcnt(8)
  s_add_u32 m0, s82, 65536
  s_add_u32 s100, s100, 0x8000
  s_cmp_eq_u32 s100, 458752
  s_cselect_b32 s100, 0, s100
  s_add_u32 s84, s100, s83
  buffer_load_dwordx4 v12, s[72:75], s84 offen offset:0 lds
  buffer_load_dwordx4 v13, s[72:75], s84 offen offset:1024 lds
  buffer_load_dwordx4 v14, s[72:75], s84 offen offset:2048 lds
  buffer_load_dwordx4 v15, s[72:75], s84 offen offset:3072 lds
  buffer_load_dwordx2 v[28:29], v26, s[52:55], s97 offen sc1
  s_waitcnt vmcnt(17)
  s_mov_b64 exec, 1
  buffer_store_dwordx2 v[16:17], v9, s[52:55], s28 offen sc1
  s_mov_b64 exec, -1
  s_waitcnt vmcnt(1)
  v_cmp_ne_u64 vcc, v[28:29], v[16:17]
  s_cbranch_vccz L_hokA
  s_mov_b32 s4, 0
Lc8:
  buffer_load_dwordx2 v[28:29], v26, s[52:55], s97 offen sc1
  s_add_u32 s4, s4, 1
  s_waitcnt vmcnt(0)
  v_cmp_ne_u64 vcc, v[28:29], v[16:17]
  s_cmp_ge_u32 s4, 30000
  s_cbranch_scc1 Lc8_x
  s_cbranch_vccz Lc8_x
  s_sleep 2
  s_branch Lc8
Lc8_x:
L_hokA:
  s_add_u32 s97, s97, 512
  s_setprio 2
  buffer_load_dwordx4 v[32:35], v2, s[52:55], s56 offen sc1
  buffer_load_dwordx4 v[36:39], v4, s[52:55], s56 offen sc1
  buffer_load_dwordx4 v[40:43], v2, s[52:55], s57 offen sc1
  buffer_load_dwordx4 v[44:47], v4, s[52:55], s57 offen sc1
  buffer_load_dwordx4 v[48:51], v2, s[52:55], s58 offen sc1
  buffer_load_dwordx4 v[52:55], v4, s[52:55], s58 offen sc1
  buffer_load_dwordx4 v[56:59], v2, s[52:55], s59 offen sc1
  buffer_load_dwordx4 v[60:63], v4, s[52:55], s59 offen sc1
  s_waitcnt vmcnt(7)
  v_mfma_f32_16x16x32_bf16 v[64:67], v[208:211], v[32:35], 0
  s_waitcnt lgkmcnt(0)
  s_add_u32 m0, s82, 0
  s_add_u32 s100, s100, 0x8000
  s_cmp_eq_u32 s100, 458752
  s_cselect_b32 s100, 0, s100
  s_add_u32 s84, s100, s83
  buffer_load_dwordx4 v12, s[72:75], s84 offen offset:0 lds
  v_mfma_f32_16x16x32_bf16 v[68:71], v[212:215], v[32:35], 0
  buffer_load_dwordx4 v13, s[72:75], s84 offen offset:1024 lds
  v_mfma_f32_16x16x32_bf16 v[72:75], v[216:219], v[32:35], 0
  buffer_load_dwordx4 v14, s[72:75], s84 offen offset:2048 lds
  v_mfma_f32_16x16x32_bf16 v[76:79], v[220:223], v[32:35], 0
  buffer_load_dwordx4 v15, s[72:75], s84 offen offset:3072 lds
  s_cmp_lg_u32 s8, 0
  s_cbranch_scc1 L_nohok
  s_mov_b64 exec, 1
  ds_add_u32 v10, v11 offset:136
  s_mov_b64 exec, -1
L_nohok:
  s_waitcnt vmcnt(10)
  v_mfma_f32_16x16x32_bf16 v[80:83], v[208:211], v[36:39], 0
  buffer_load_dwordx4 v[32:35], v2, s[52:55], s60 offen sc1
  v_mfma_f32_16x16x32_bf16 v[84:87], v[212:215], v[36:39], 0
  ds_read_b64_tr_b16 v[128:129], v22 offset:20480
  v_mfma_f32_16x16x32_bf16 v[88:91], v[216:219], v[36:39], 0
  ds_read_b64_tr_b16 v[130:131], v22 offset:20992
  v_mfma_f32_16x16x32_bf16 v[92:95], v[220:223], v[36:39], 0
  ds_read_b64_tr_b16 v[136:137], v23 offset:20480
  s_waitcnt vmcnt(10)
  v_mfma_f32_16x16x32_bf16 v[64:67], v[224:227], v[40:43], v[64:67]
  buffer_load_dwordx4 v[36:39], v4, s[52:55], s60 offen sc1
  v_mfma_f32_16x16x32_bf16 v[68:71], v[228:231], v[40:43], v[68:71]
  ds_read_b64_tr_b16 v[138:139], v23 offset:20992
  v_mfma_f32_16x16x32_bf16 v[72:75], v[232:235], v[40:43], v[72:75]
  ds_read_b64_tr_b16 v[140:141], v24 offset:20480
  v_mfma_f32_16x16x32_bf16 v[76:79], v[236:239], v[40:43], v[76:79]
  ds_read_b64_tr_b16 v[142:143], v24 offset:20992
  s_waitcnt vmcnt(10)
  v_mfma_f32_16x16x32_bf16 v[80:83], v[224:227], v[44:47], v[80:83]
  buffer_load_dwordx4 v[40:43], v2, s[52:55], s61 offen sc1
  v_mfma_f32_16x16x32_bf16 v[84:87], v[228:231], v[44:47], v[84:87]
  ds_read_b64_tr_b16 v[192:193], v25 offset:20480
  v_mfma_f32_16x16x32_bf16 v[88:91], v[232:235], v[44:47], v[88:91]
  ds_read_b64_tr_b16 v[194:195], v25 offset:20992
  v_mfma_f32_16x16x32_bf16 v[92:95], v[236:239], v[44:47], v[92:95]
  s_waitcnt lgkmcnt(0)
  s_add_u32 m0, s82, 86016
  s_add_u32 s100, s100, 0x8000
  s_cmp_eq_u32 s100, 458752
  s_cselect_b32 s100, 0, s100
  s_add_u32 s84, s100, s83
  buffer_load_dwordx4 v12, s[72:75], s84 offen offset:0 lds
  s_waitcnt vmcnt(11)
  v_mfma_f32_16x16x32_bf16 v[64:67], v[100:103], v[48:51], v[64:67]
  buffer_load_dwordx4 v[44:47], v4, s[52:55], s61 offen sc1
  v_mfma_f32_16x16x32_bf16 v[68:71], v[108:111], v[48:51], v[68:71]
  buffer_load_dwordx4 v13, s[72:75], s84 offen offset:1024 lds
  v_mfma_f32_16x16x32_bf16 v[72:75], v[116:119], v[48:51], v[72:75]
  buffer_load_dwordx4 v14, s[72:75], s84 offen offset:2048 lds
  v_mfma_f32_16x16x32_bf16 v[76:79], v[124:127], v[48:51], v[76:79]
  buffer_load_dwordx4 v15, s[72:75], s84 offen offset:3072 lds
  s_waitcnt vmcnt(14)
  v_mfma_f32_16x16x32_bf16 v[80:83], v[100:103], v[52:55], v[80:83]
  buffer_load_dwordx4 v[48:51], v2, s[52:55], s62 offen sc1
  v_mfma_f32_16x16x32_bf16 v[84:87], v[108:111], v[52:55], v[84:87]
  ds_read_b64_tr_b16 v[144:145], v22 offset:36864
  v_mfma_f32_16x16x32_bf16 v[88:91], v[116:119], v[52:55], v[88:91]
  ds_read_b64_tr_b16 v[146:147], v22 offset:37376
  v_mfma_f32_16x16x32_bf16 v[92:95], v[124:127], v[52:55], v[92:95]
  ds_read_b64_tr_b16 v[148:149], v23 offset:36864
  s_waitcnt vmcnt(14)
  v_mfma_f32_16x16x32_bf16 v[64:67], v[132:135], v[56:59], v[64:67]
  buffer_load_dwordx4 v[52:55], v4, s[52:55], s62 offen sc1
  v_mfma_f32_16x16x32_bf16 v[68:71], v[200:203], v[56:59], v[68:71]
  ds_read_b64_tr_b16 v[150:151], v23 offset:37376
  v_mfma_f32_16x16x32_bf16 v[72:75], v[204:207], v[56:59], v[72:75]
  ds_read_b64_tr_b16 v[152:153], v24 offset:36864
  v_mfma_f32_16x16x32_bf16 v[76:79], v[252:255], v[56:59], v[76:79]
  ds_read_b64_tr_b16 v[154:155], v24 offset:37376
  s_waitcnt vmcnt(14)
  v_mfma_f32_16x16x32_bf16 v[80:83], v[132:135], v[60:63], v[80:83]
  buffer_load_dwordx4 v[56:59], v2, s[52:55], s63 offen sc1
  v_mfma_f32_16x16x32_bf16 v[84:87], v[200:203], v[60:63], v[84:87]
  ds_read_b64_tr_b16 v[156:157], v25 offset:36864
  v_mfma_f32_16x16x32_bf16 v[88:91], v[204:207], v[60:63], v[88:91]
  ds_read_b64_tr_b16 v[158:159], v25 offset:37376
  v_mfma_f32_16x16x32_bf16 v[92:95], v[252:255], v[60:63], v[92:95]
  s_waitcnt lgkmcnt(0)
  s_add_u32 m0, s82, 102400
  s_add_u32 s100, s100, 0x8000
  s_cmp_eq_u32 s100, 458752
  s_cselect_b32 s100, 0, s100
  s_add_u32 s84, s100, s83
  buffer_load_dwordx4 v12, s[72:75], s84 offen offset:0 lds
  s_waitcnt vmcnt(11)
  v_mfma_f32_16x16x32_bf16 v[64:67], v[96:99], v[32:35], v[64:67]
  buffer_load_dwordx4 v[60:63], v4, s[52:55], s63 offen sc1
  v_mfma_f32_16x16x32_bf16 v[68:71], v[104:107], v[32:35], v[68:71]
  buffer_load_dwordx4 v13, s[72:75], s84 offen offset:1024 lds
  v_mfma_f32_16x16x32_bf16 v[72:75], v[112:115], v[32:35], v[72:75]
  buffer_load_dwordx4 v14, s[72:75], s84 offen offset:2048 lds
  v_mfma_f32_16x16x32_bf16 v[76:79], v[120:123], v[32:35], v[76:79]
  buffer_load_dwordx4 v15, s[72:75], s84 offen offset:3072 lds
  s_waitcnt vmcnt(14)
  v_mfma_f32_16x16x32_bf16 v[80:83], v[96:99], v[36:39], v[80:83]
  buffer_load_dwordx4 v[32:35], v2, s[52:55], s64 offen sc1
  v_mfma_f32_16x16x32_bf16 v[84:87], v[104:107], v[36:39], v[84:87]
  ds_read_b64_tr_b16 v[160:161], v18 offset:49152
  v_mfma_f32_16x16x32_bf16 v[88:91], v[112:115], v[36:39], v[88:91]
  ds_read_b64_tr_b16 v[162:163], v18 offset:49664
  v_mfma_f32_16x16x32_bf16 v[92:95], v[120:123], v[36:39], v[92:95]
  ds_read_b64_tr_b16 v[164:165], v19 offset:49152
  s_waitcnt vmcnt(14)
  v_mfma_f32_16x16x32_bf16 v[64:67], v[128:131], v[40:43], v[64:67]
  buffer_load_dwordx4 v[36:39], v4, s[52:55], s64 offen sc1
  v_mfma_f32_16x16x32_bf16 v[68:71], v[136:139], v[40:43], v[68:71]
  ds_read_b64_tr_b16 v[166:167], v19 offset:49664
  v_mfma_f32_16x16x32_bf16 v[72:75], v[140:143], v[40:43], v[72:75]
  ds_read_b64_tr_b16 v[168:169], v20 offset:49152
  v_mfma_f32_16x16x32_bf16 v[76:79], v[192:195], v[40:43], v[76:79]
  ds_read_b64_tr_b16 v[170:171], v20 offset:49664
  s_waitcnt vmcnt(13)
  v_mfma_f32_16x16x32_bf16 v[80:83], v[128:131], v[44:47], v[80:83]
  buffer_load_dwordx4 v[40:43], v2, s[52:55], s65 offen sc1
  v_mfma_f32_16x16x32_bf16 v[84:87], v[136:139], v[44:47], v[84:87]
  ds_read_b64_tr_b16 v[172:173], v21 offset:49152
  v_mfma_f32_16x16x32_bf16 v[88:91], v[140:143], v[44:47], v[88:91]
  ds_read_b64_tr_b16 v[174:175], v21 offset:49664
  v_mfma_f32_16x16x32_bf16 v[92:95], v[192:195], v[44:47], v[92:95]
  s_waitcnt lgkmcnt(0)
  s_add_u32 m0, s82, 49152
  s_add_u32 s100, s100, 0x8000
  s_cmp_eq_u32 s100, 458752
  s_cselect_b32 s100, 0, s100
  s_add_u32 s84, s100, s83
  buffer_load_dwordx4 v12, s[72:75], s84 offen offset:0 lds
  buffer_load_dwordx2 v[28:29], v26, s[52:55], s97 offen sc1
  s_waitcnt vmcnt(12)
  v_mfma_f32_16x16x32_bf16 v[64:67], v[144:147], v[48:51], v[64:67]
  buffer_load_dwordx4 v[44:47], v4, s[52:55], s65 offen sc1
  v_mfma_f32_16x16x32_bf16 v[68:71], v[148:151], v[48:51], v[68:71]
  buffer_load_dwordx4 v13, s[72:75], s84 offen offset:1024 lds
  v_mfma_f32_16x16x32_bf16 v[72:75], v[152:155], v[48:51], v[72:75]
  buffer_load_dwordx4 v14, s[72:75], s84 offen offset:2048 lds
  v_mfma_f32_16x16x32_bf16 v[76:79], v[156:159], v[48:51], v[76:79]
  buffer_load_dwordx4 v15, s[72:75], s84 offen offset:3072 lds
  s_waitcnt vmcnt(15)
  v_mfma_f32_16x16x32_bf16 v[80:83], v[144:147], v[52:55], v[80:83]
  buffer_load_dwordx4 v[48:51], v2, s[52:55], s66 offen sc1
  v_mfma_f32_16x16x32_bf16 v[84:87], v[148:151], v[52:55], v[84:87]
  ds_read_b64_tr_b16 v[176:177], v22 offset:0
  v_mfma_f32_16x16x32_bf16 v[88:91], v[152:155], v[52:55], v[88:91]
  ds_read_b64_tr_b16 v[178:179], v22 offset:512
  v_mfma_f32_16x16x32_bf16 v[92:95], v[156:159], v[52:55], v[92:95]
  ds_read_b64_tr_b16 v[180:181], v23 offset:0
  s_waitcnt vmcnt(15)
  v_mfma_f32_16x16x32_bf16 v[64:67], v[160:163], v[56:59], v[64:67]
  buffer_load_dwordx4 v[52:55], v4, s[52:55], s66 offen sc1
  v_mfma_f32_16x16x32_bf16 v[68:71], v[164:167], v[56:59], v[68:71]
  ds_read_b64_tr_b16 v[182:183], v23 offset:512
  v_mfma_f32_16x16x32_bf16 v[72:75], v[168:171], v[56:59], v[72:75]
  ds_read_b64_tr_b16 v[184:185], v24 offset:0
  v_mfma_f32_16x16x32_bf16 v[76:79], v[172:175], v[56:59], v[76:79]
  ds_read_b64_tr_b16 v[186:187], v24 offset:512
  s_waitcnt vmcnt(14)
  v_mfma_f32_16x16x32_bf16 v[80:83], v[160:163], v[60:63], v[80:83]
  buffer_load_dwordx4 v[56:59], v2, s[52:55], s67 offen sc1
  v_mfma_f32_16x16x32_bf16 v[84:87], v[164:167], v[60:63], v[84:87]
  ds_read_b64_tr_b16 v[188:189], v25 offset:0
  v_mfma_f32_16x16x32_bf16 v[88:91], v[168:171], v[60:63], v[88:91]
  ds_read_b64_tr_b16 v[190:191], v25 offset:512
  v_mfma_f32_16x16x32_bf16 v[92:95], v[172:175], v[60:63], v[92:95]
  s_waitcnt lgkmcnt(0)
  s_add_u32 m0, s82, 65536
  s_add_u32 s100, s100, 0x8000
  s_cmp_eq_u32 s100, 458752
  s_cselect_b32 s100, 0, s100
  s_add_u32 s84, s100, s83
  buffer_load_dwordx4 v12, s[72:75], s84 offen offset:0 lds
  s_waitcnt vmcnt(12)
  v_mfma_f32_16x16x32_bf16 v[64:67], v[176:179], v[32:35], v[64:67]
  buffer_load_dwordx4 v[60:63], v4, s[52:55], s67 offen sc1
  v_mfma_f32_16x16x32_bf16 v[68:71], v[180:183], v[32:35], v[68:71]
  buffer_load_dwordx4 v13, s[72:75], s84 offen offset:1024 lds
  v_mfma_f32_16x16x32_bf16 v[72:75], v[184:187], v[32:35], v[72:75]
  buffer_load_dwordx4 v14, s[72:75], s84 offen offset:2048 lds
  v_mfma_f32_16x16x32_bf16 v[76:79], v[188:191], v[32:35], v[76:79]
  buffer_load_dwordx4 v15, s[72:75], s84 offen offset:3072 lds
  s_mov_b64 exec, 1
  ds_add_u32 v10, v11 offset:140
  s_mov_b64 exec, -1
  s_waitcnt vmcnt(15)
  v_mfma_f32_16x16x32_bf16 v[80:83], v[176:179], v[36:39], v[80:83]
  buffer_load_dwordx4 v[32:35], v2, s[52:55], s68 offen sc1
  v_mfma_f32_16x16x32_bf16 v[84:87], v[180:183], v[36:39], v[84:87]
  ds_read_b64_tr_b16 v[240:241], v18 offset:0
  v_mfma_f32_16x16x32_bf16 v[88:91], v[184:187], v[36:39], v[88:91]
  ds_read_b64_tr_b16 v[242:243], v18 offset:512
  v_mfma_f32_16x16x32_bf16 v[92:95], v[188:191], v[36:39], v[92:95]
  ds_read_b64_tr_b16 v[244:245], v19 offset:0
  ds_read_b64_tr_b16 v[246:247], v19 offset:512
  ds_read_b64_tr_b16 v[248:249], v20 offset:0
  ds_read_b64_tr_b16 v[250:251], v20 offset:512
  ds_read_b64_tr_b16 v[196:197], v21 offset:0
  ds_read_b64_tr_b16 v[198:199], v21 offset:512
  s_waitcnt vmcnt(15) lgkmcnt(0)
  v_mfma_f32_16x16x32_bf16 v[64:67], v[240:243], v[40:43], v[64:67]
  buffer_load_dwordx4 v[36:39], v4, s[52:55], s68 offen sc1
  v_mfma_f32_16x16x32_bf16 v[68:71], v[244:247], v[40:43], v[68:71]
  v_mfma_f32_16x16x32_bf16 v[72:75], v[248:251], v[40:43], v[72:75]
  v_mfma_f32_16x16x32_bf16 v[76:79], v[196:199], v[40:43], v[76:79]
  s_waitcnt vmcnt(13)
  v_mfma_f32_16x16x32_bf16 v[80:83], v[240:243], v[44:47], v[80:83]
  buffer_load_dwordx4 v[40:43], v2, s[52:55], s69 offen sc1
  v_mfma_f32_16x16x32_bf16 v[84:87], v[244:247], v[44:47], v[84:87]
  v_mfma_f32_16x16x32_bf16 v[88:91], v[248:251], v[44:47], v[88:91]
  v_mfma_f32_16x16x32_bf16 v[92:95], v[196:199], v[44:47], v[92:95]
  ds_read_b64_tr_b16 v[240:241], v22 offset:20480
  ds_read_b64_tr_b16 v[242:243], v22 offset:20992
  ds_read_b64_tr_b16 v[244:245], v23 offset:20480
  ds_read_b64_tr_b16 v[246:247], v23 offset:20992
  ds_read_b64_tr_b16 v[248:249], v24 offset:20480
  ds_read_b64_tr_b16 v[250:251], v24 offset:20992
  ds_read_b64_tr_b16 v[196:197], v25 offset:20480
  ds_read_b64_tr_b16 v[198:199], v25 offset:20992
  s_waitcnt vmcnt(10) lgkmcnt(0)
  v_mfma_f32_16x16x32_bf16 v[64:67], v[240:243], v[48:51], v[64:67]
  buffer_load_dwordx4 v[44:47], v4, s[52:55], s69 offen sc1
  v_mfma_f32_16x16x32_bf16 v[68:71], v[244:247], v[48:51], v[68:71]
  v_mfma_f32_16x16x32_bf16 v[72:75], v[248:251], v[48:51], v[72:75]
  v_mfma_f32_16x16x32_bf16 v[76:79], v[196:199], v[48:51], v[76:79]
  s_waitcnt vmcnt(10)
  v_mfma_f32_16x16x32_bf16 v[80:83], v[240:243], v[52:55], v[80:83]
  v_cmp_ne_u64 vcc, v[28:29], v[16:17]
  s_cbranch_vccz L_hokB
  s_mov_b32 s4, 0
Lc9:
  buffer_load_dwordx2 v[28:29], v26, s[52:55], s97 offen sc1
  s_add_u32 s4, s4, 1
  s_waitcnt vmcnt(0)
  v_cmp_ne_u64 vcc, v[28:29], v[16:17]
  s_cmp_ge_u32 s4, 30000
  s_cbranch_scc1 Lc9_x
  s_cbranch_vccz Lc9_x
  s_sleep 2
  s_branch Lc9
Lc9_x:
L_hokB:
  buffer_load_dwordx4 v[48:51], v3, s[52:55], s69 offen sc1
  v_mfma_f32_16x16x32_bf16 v[84:87], v[244:247], v[52:55], v[84:87]
  v_mfma_f32_16x16x32_bf16 v[88:91], v[248:251], v[52:55], v[88:91]
  v_mfma_f32_16x16x32_bf16 v[92:95], v[196:199], v[52:55], v[92:95]
  ds_read_b64_tr_b16 v[240:241], v22 offset:36864
  ds_read_b64_tr_b16 v[242:243], v22 offset:37376
  ds_read_b64_tr_b16 v[244:245], v23 offset:36864
  ds_read_b64_tr_b16 v[246:247], v23 offset:37376
  ds_read_b64_tr_b16 v[248:249], v24 offset:36864
  ds_read_b64_tr_b16 v[250:251], v24 offset:37376
  ds_read_b64_tr_b16 v[196:197], v25 offset:36864
  ds_read_b64_tr_b16 v[198:199], v25 offset:37376
  s_waitcnt vmcnt(10) lgkmcnt(0)
  v_mfma_f32_16x16x32_bf16 v[64:67], v[240:243], v[56:59], v[64:67]
  buffer_load_dwordx4 v[52:55], v5, s[52:55], s69 offen sc1
  v_mfma_f32_16x16x32_bf16 v[68:71], v[244:247], v[56:59], v[68:71]
  v_mfma_f32_16x16x32_bf16 v[72:75], v[248:251], v[56:59], v[72:75]
  v_mfma_f32_16x16x32_bf16 v[76:79], v[196:199], v[56:59], v[76:79]
  s_waitcnt vmcnt(9)
  v_mfma_f32_16x16x32_bf16 v[80:83], v[240:243], v[60:63], v[80:83]
  buffer_load_dwordx4 v[56:59], v3, s[52:55], s56 offen sc1
  v_mfma_f32_16x16x32_bf16 v[84:87], v[244:247], v[60:63], v[84:87]
  v_mfma_f32_16x16x32_bf16 v[88:91], v[248:251], v[60:63], v[88:91]
  v_mfma_f32_16x16x32_bf16 v[92:95], v[196:199], v[60:63], v[92:95]
  ds_read_b64_tr_b16 v[240:241], v18 offset:49152
  ds_read_b64_tr_b16 v[242:243], v18 offset:49664
  ds_read_b64_tr_b16 v[244:245], v19 offset:49152
  ds_read_b64_tr_b16 v[246:247], v19 offset:49664
  ds_read_b64_tr_b16 v[248:249], v20 offset:49152
  ds_read_b64_tr_b16 v[250:251], v20 offset:49664
  ds_read_b64_tr_b16 v[196:197], v21 offset:49152
  ds_read_b64_tr_b16 v[198:199], v21 offset:49664
  s_waitcnt vmcnt(6) lgkmcnt(0)
  v_mfma_f32_16x16x32_bf16 v[64:67], v[240:243], v[32:35], v[64:67]
  buffer_load_dwordx4 v[60:63], v5, s[52:55], s56 offen sc1
  v_mfma_f32_16x16x32_bf16 v[68:71], v[244:247], v[32:35], v[68:71]
  v_mfma_f32_16x16x32_bf16 v[72:75], v[248:251], v[32:35], v[72:75]
  v_mfma_f32_16x16x32_bf16 v[76:79], v[196:199], v[32:35], v[76:79]
  s_waitcnt vmcnt(6)
  v_mfma_f32_16x16x32_bf16 v[80:83], v[240:243], v[36:39], v[80:83]
  buffer_load_dwordx4 v[32:35], v3, s[52:55], s68 offen sc1
  v_mfma_f32_16x16x32_bf16 v[84:87], v[244:247], v[36:39], v[84:87]
  v_mfma_f32_16x16x32_bf16 v[88:91], v[248:251], v[36:39], v[88:91]
  v_mfma_f32_16x16x32_bf16 v[92:95], v[196:199], v[36:39], v[92:95]
  ds_read_b64_tr_b16 v[240:241], v22 offset:0
  ds_read_b64_tr_b16 v[242:243], v22 offset:512
  ds_read_b64_tr_b16 v[244:245], v23 offset:0
  ds_read_b64_tr_b16 v[246:247], v23 offset:512
  ds_read_b64_tr_b16 v[248:249], v24 offset:0
  ds_read_b64_tr_b16 v[250:251], v24 offset:512
  ds_read_b64_tr_b16 v[196:197], v25 offset:0
  ds_read_b64_tr_b16 v[198:199], v25 offset:512
  s_waitcnt vmcnt(6) lgkmcnt(0)
  v_mfma_f32_16x16x32_bf16 v[64:67], v[240:243], v[40:43], v[64:67]
  buffer_load_dwordx4 v[36:39], v5, s[52:55], s68 offen sc1
  v_mfma_f32_16x16x32_bf16 v[68:71], v[244:247], v[40:43], v[68:71]
  v_mfma_f32_16x16x32_bf16 v[72:75], v[248:251], v[40:43], v[72:75]
  v_mfma_f32_16x16x32_bf16 v[76:79], v[196:199], v[40:43], v[76:79]
  s_waitcnt vmcnt(6)
  v_mfma_f32_16x16x32_bf16 v[80:83], v[240:243], v[44:47], v[80:83]
  buffer_load_dwordx4 v[40:43], v3, s[52:55], s57 offen sc1
  v_mfma_f32_16x16x32_bf16 v[84:87], v[244:247], v[44:47], v[84:87]
  v_mfma_f32_16x16x32_bf16 v[88:91], v[248:251], v[44:47], v[88:91]
  v_mfma_f32_16x16x32_bf16 v[92:95], v[196:199], v[44:47], v[92:95]
Lc10:
  ds_read_b32 v8, v10 offset:132
  s_waitcnt lgkmcnt(0)
  v_cmp_gt_u32 vcc, 4, v8
  s_cbranch_vccz Lc10_x
  s_sub_u32 s30, s30, 1
  s_cmp_gt_i32 s30, 0
  s_cbranch_scc1 Lc10
Lc10_x:
  ds_write_b128 v30, v[64:67] offset:0
  ds_write_b128 v30, v[68:71] offset:4096
  ds_write_b128 v30, v[72:75] offset:8192
  ds_write_b128 v30, v[76:79] offset:12288
  s_mov_b64 exec, 1
  ds_add_u32 v10, v11 offset:112
  s_mov_b64 exec, -1
  ds_write_b128 v30, v[80:83] offset:16384
  ds_write_b128 v30, v[84:87] offset:20480
  ds_write_b128 v30, v[88:91] offset:24576
  ds_write_b128 v30, v[92:95] offset:28672
  s_mov_b64 exec, 1
  ds_add_u32 v10, v11 offset:120
  s_mov_b64 exec, -1
  s_waitcnt lgkmcnt(1)
  s_waitcnt vmcnt(6)
  v_mfma_f32_16x16x32_bf16 v[64:67], v[240:243], v[48:51], 0
  buffer_load_dwordx4 v[44:47], v5, s[52:55], s57 offen sc1
  v_mfma_f32_16x16x32_bf16 v[68:71], v[244:247], v[48:51], 0
  v_mfma_f32_16x16x32_bf16 v[72:75], v[248:251], v[48:51], 0
  v_mfma_f32_16x16x32_bf16 v[76:79], v[196:199], v[48:51], 0
  s_waitcnt vmcnt(6)
  v_mfma_f32_16x16x32_bf16 v[80:83], v[240:243], v[52:55], 0
  buffer_load_dwordx4 v[48:51], v3, s[52:55], s67 offen sc1
  v_mfma_f32_16x16x32_bf16 v[84:87], v[244:247], v[52:55], 0
  v_mfma_f32_16x16x32_bf16 v[88:91], v[248:251], v[52:55], 0
  v_mfma_f32_16x16x32_bf16 v[92:95], v[196:199], v[52:55], 0
  s_waitcnt vmcnt(6)
  v_mfma_f32_16x16x32_bf16 v[64:67], v[208:211], v[56:59], v[64:67]
  buffer_load_dwordx4 v[52:55], v5, s[52:55], s67 offen sc1
  v_mfma_f32_16x16x32_bf16 v[68:71], v[212:215], v[56:59], v[68:71]
  ds_read_b64_tr_b16 v[240:241], v18 offset:49152
  v_mfma_f32_16x16x32_bf16 v[72:75], v[216:219], v[56:59], v[72:75]
  ds_read_b64_tr_b16 v[242:243], v18 offset:49664
  v_mfma_f32_16x16x32_bf16 v[76:79], v[220:223], v[56:59], v[76:79]
  ds_read_b64_tr_b16 v[244:245], v19 offset:49152
  s_waitcnt vmcnt(6)
  v_mfma_f32_16x16x32_bf16 v[80:83], v[208:211], v[60:63], v[80:83]
  buffer_load_dwordx4 v[56:59], v3, s[52:55], s58 offen sc1
  v_mfma_f32_16x16x32_bf16 v[84:87], v[212:215], v[60:63], v[84:87]
  ds_read_b64_tr_b16 v[246:247], v19 offset:49664
  v_mfma_f32_16x16x32_bf16 v[88:91], v[216:219], v[60:63], v[88:91]
  ds_read_b64_tr_b16 v[248:249], v20 offset:49152
  v_mfma_f32_16x16x32_bf16 v[92:95], v[220:223], v[60:63], v[92:95]
  ds_read_b64_tr_b16 v[250:251], v20 offset:49664
  ds_read_b64_tr_b16 v[196:197], v21 offset:49152
  ds_read_b64_tr_b16 v[198:199], v21 offset:49664
  s_waitcnt vmcnt(6) lgkmcnt(0)
  v_mfma_f32_16x16x32_bf16 v[64:67], v[240:243], v[32:35], v[64:67]
  buffer_load_dwordx4 v[60:63], v5, s[52:55], s58 offen sc1
  v_mfma_f32_16x16x32_bf16 v[68:71], v[244:247], v[32:35], v[68:71]
  v_mfma_f32_16x16x32_bf16 v[72:75], v[248:251], v[32:35], v[72:75]
  buffer_load_dwordx4 v[208:211], v3, s[52:55], s66 offen sc1
  v_mfma_f32_16x16x32_bf16 v[76:79], v[196:199], v[32:35], v[76:79]
  s_waitcnt vmcnt(7)
  v_mfma_f32_16x16x32_bf16 v[80:83], v[240:243], v[36:39], v[80:83]
  buffer_load_dwordx4 v[212:215], v5, s[52:55], s66 offen sc1
  v_mfma_f32_16x16x32_bf16 v[84:87], v[244:247], v[36:39], v[84:87]
  v_mfma_f32_16x16x32_bf16 v[88:91], v[248:251], v[36:39], v[88:91]
  buffer_load_dwordx4 v[216:219], v3, s[52:55], s59 offen sc1
  v_mfma_f32_16x16x32_bf16 v[92:95], v[196:199], v[36:39], v[92:95]
  s_waitcnt vmcnt(8)
  v_mfma_f32_16x16x32_bf16 v[64:67], v[224:227], v[40:43], v[64:67]
  buffer_load_dwordx4 v[220:223], v5, s[52:55], s59 offen sc1
  v_mfma_f32_16x16x32_bf16 v[68:71], v[228:231], v[40:43], v[68:71]
  ds_read_b64_tr_b16 v[240:241], v22 offset:36864
  v_mfma_f32_16x16x32_bf16 v[72:75], v[232:235], v[40:43], v[72:75]
  buffer_load_dwordx4 v[32:35], v3, s[52:55], s65 offen sc1
  v_mfma_f32_16x16x32_bf16 v[76:79], v[236:239], v[40:43], v[76:79]
  ds_read_b64_tr_b16 v[242:243], v22 offset:37376
  s_waitcnt vmcnt(9)
  v_mfma_f32_16x16x32_bf16 v[80:83], v[224:227], v[44:47], v[80:83]
  buffer_load_dwordx4 v[36:39], v5, s[52:55], s65 offen sc1
  v_mfma_f32_16x16x32_bf16 v[84:87], v[228:231], v[44:47], v[84:87]
  ds_read_b64_tr_b16 v[244:245], v23 offset:36864
  v_mfma_f32_16x16x32_bf16 v[88:91], v[232:235], v[44:47], v[88:91]
  buffer_load_dwordx4 v[40:43], v3, s[52:55], s60 offen sc1
  v_mfma_f32_16x16x32_bf16 v[92:95], v[236:239], v[44:47], v[92:95]
  ds_read_b64_tr_b16 v[246:247], v23 offset:37376
  ds_read_b64_tr_b16 v[248:249], v24 offset:36864
  ds_read_b64_tr_b16 v[250:251], v24 offset:37376
  ds_read_b64_tr_b16 v[196:197], v25 offset:36864
  ds_read_b64_tr_b16 v[198:199], v25 offset:37376
  s_waitcnt vmcnt(10) lgkmcnt(0)
  v_mfma_f32_16x16x32_bf16 v[64:67], v[240:243], v[48:51], v[64:67]
  buffer_load_dwordx4 v[44:47], v5, s[52:55], s60 offen sc1
  v_mfma_f32_16x16x32_bf16 v[68:71], v[244:247], v[48:51], v[68:71]
  v_mfma_f32_16x16x32_bf16 v[72:75], v[248:251], v[48:51], v[72:75]
  buffer_load_dwordx4 v[224:227], v3, s[52:55], s61 offen sc1
  v_mfma_f32_16x16x32_bf16 v[76:79], v[196:199], v[48:51], v[76:79]
  s_waitcnt vmcnt(11)
  v_mfma_f32_16x16x32_bf16 v[80:83], v[240:243], v[52:55], v[80:83]
  buffer_load_dwordx4 v[228:231], v3, s[52:55], s62 offen sc1
  v_mfma_f32_16x16x32_bf16 v[84:87], v[244:247], v[52:55], v[84:87]
  v_mfma_f32_16x16x32_bf16 v[88:91], v[248:251], v[52:55], v[88:91]
  buffer_load_dwordx4 v[232:235], v3, s[52:55], s63 offen sc1
  v_mfma_f32_16x16x32_bf16 v[92:95], v[196:199], v[52:55], v[92:95]
  s_waitcnt vmcnt(12)
  v_mfma_f32_16x16x32_bf16 v[64:67], v[100:103], v[56:59], v[64:67]
  buffer_load_dwordx4 v[236:239], v3, s[52:55], s64 offen sc1
  v_mfma_f32_16x16x32_bf16 v[68:71], v[108:111], v[56:59], v[68:71]
  ds_read_b64_tr_b16 v[240:241], v22 offset:20480
  v_mfma_f32_16x16x32_bf16 v[72:75], v[116:119], v[56:59], v[72:75]
  ds_read_b64_tr_b16 v[242:243], v22 offset:20992
  v_mfma_f32_16x16x32_bf16 v[76:79], v[124:127], v[56:59], v[76:79]
  ds_read_b64_tr_b16 v[244:245], v23 offset:20480
  s_waitcnt vmcnt(12)
  v_mfma_f32_16x16x32_bf16 v[80:83], v[100:103], v[60:63], v[80:83]
  buffer_load_dwordx4 v[48:51], v5, s[52:55], s61 offen sc1
  v_mfma_f32_16x16x32_bf16 v[84:87], v[108:111], v[60:63], v[84:87]
  ds_read_b64_tr_b16 v[246:247], v23 offset:20992
  v_mfma_f32_16x16x32_bf16 v[88:91], v[116:119], v[60:63], v[88:91]
  ds_read_b64_tr_b16 v[248:249], v24 offset:20480
  v_mfma_f32_16x16x32_bf16 v[92:95], v[124:127], v[60:63], v[92:95]
  ds_read_b64_tr_b16 v[250:251], v24 offset:20992
  ds_read_b64_tr_b16 v[196:197], v25 offset:20480
  ds_read_b64_tr_b16 v[198:199], v25 offset:20992
  s_waitcnt vmcnt(12) lgkmcnt(0)
  v_mfma_f32_16x16x32_bf16 v[64:67], v[240:243], v[208:211], v[64:67]
  buffer_load_dwordx4 v[52:55], v5, s[52:55], s62 offen sc1
  v_mfma_f32_16x16x32_bf16 v[68:71], v[244:247], v[208:211], v[68:71]
  v_mfma_f32_16x16x32_bf16 v[72:75], v[248:251], v[208:211], v[72:75]
  v_mfma_f32_16x16x32_bf16 v[76:79], v[196:199], v[208:211], v[76:79]
  s_waitcnt vmcnt(12)
  v_mfma_f32_16x16x32_bf16 v[80:83], v[240:243], v[212:215], v[80:83]
  buffer_load_dwordx4 v[56:59], v5, s[52:55], s63 offen sc1
  v_mfma_f32_16x16x32_bf16 v[84:87], v[244:247], v[212:215], v[84:87]
  v_mfma_f32_16x16x32_bf16 v[88:91], v[248:251], v[212:215], v[88:91]
  v_mfma_f32_16x16x32_bf16 v[92:95], v[196:199], v[212:215], v[92:95]
  s_waitcnt vmcnt(12)
  v_mfma_f32_16x16x32_bf16 v[64:67], v[132:135], v[216:219], v[64:67]
  buffer_load_dwordx4 v[60:63], v5, s[52:55], s64 offen sc1
  v_mfma_f32_16x16x32_bf16 v[68:71], v[200:203], v[216:219], v[68:71]
  ds_read_b64_tr_b16 v[240:241], v18 offset:0
  v_mfma_f32_16x16x32_bf16 v[72:75], v[204:207], v[216:219], v[72:75]
  ds_read_b64_tr_b16 v[242:243], v18 offset:512
  v_mfma_f32_16x16x32_bf16 v[76:79], v[252:255], v[216:219], v[76:79]
  ds_read_b64_tr_b16 v[244:245], v19 offset:0
  s_waitcnt vmcnt(12)
  v_mfma_f32_16x16x32_bf16 v[80:83], v[132:135], v[220:223], v[80:83]
  ds_read_b64_tr_b16 v[246:247], v19 offset:512
  v_mfma_f32_16x16x32_bf16 v[84:87], v[200:203], v[220:223], v[84:87]
  ds_read_b64_tr_b16 v[248:249], v20 offset:0
  v_mfma_f32_16x16x32_bf16 v[88:91], v[204:207], v[220:223], v[88:91]
  ds_read_b64_tr_b16 v[250:251], v20 offset:512
  v_mfma_f32_16x16x32_bf16 v[92:95], v[252:255], v[220:223], v[92:95]
  ds_read_b64_tr_b16 v[196:197], v21 offset:0
  ds_read_b64_tr_b16 v[198:199], v21 offset:512
  s_waitcnt vmcnt(11) lgkmcnt(0)
  v_mfma_f32_16x16x32_bf16 v[64:67], v[240:243], v[32:35], v[64:67]
  v_mfma_f32_16x16x32_bf16 v[68:71], v[244:247], v[32:35], v[68:71]
  v_mfma_f32_16x16x32_bf16 v[72:75], v[248:251], v[32:35], v[72:75]
  v_mfma_f32_16x16x32_bf16 v[76:79], v[196:199], v[32:35], v[76:79]
  s_waitcnt vmcnt(10)
  v_mfma_f32_16x16x32_bf16 v[80:83], v[240:243], v[36:39], v[80:83]
  v_mfma_f32_16x16x32_bf16 v[84:87], v[244:247], v[36:39], v[84:87]
  v_mfma_f32_16x16x32_bf16 v[88:91], v[248:251], v[36:39], v[88:91]
  v_mfma_f32_16x16x32_bf16 v[92:95], v[196:199], v[36:39], v[92:95]
  s_waitcnt vmcnt(9)
  v_mfma_f32_16x16x32_bf16 v[64:67], v[96:99], v[40:43], v[64:67]
  v_mfma_f32_16x16x32_bf16 v[68:71], v[104:107], v[40:43], v[68:71]
  v_mfma_f32_16x16x32_bf16 v[72:75], v[112:115], v[40:43], v[72:75]
  v_mfma_f32_16x16x32_bf16 v[76:79], v[120:123], v[40:43], v[76:79]
  s_waitcnt vmcnt(8)
  v_mfma_f32_16x16x32_bf16 v[80:83], v[96:99], v[44:47], v[80:83]
  v_mfma_f32_16x16x32_bf16 v[84:87], v[104:107], v[44:47], v[84:87]
  v_mfma_f32_16x16x32_bf16 v[88:91], v[112:115], v[44:47], v[88:91]
  v_mfma_f32_16x16x32_bf16 v[92:95], v[120:123], v[44:47], v[92:95]
  s_waitcnt vmcnt(7)
  v_mfma_f32_16x16x32_bf16 v[64:67], v[128:131], v[224:227], v[64:67]
  v_mfma_f32_16x16x32_bf16 v[68:71], v[136:139], v[224:227], v[68:71]
  v_mfma_f32_16x16x32_bf16 v[72:75], v[140:143], v[224:227], v[72:75]
  v_mfma_f32_16x16x32_bf16 v[76:79], v[192:195], v[224:227], v[76:79]
  s_waitcnt vmcnt(6)
  v_mfma_f32_16x16x32_bf16 v[64:67], v[144:147], v[228:231], v[64:67]
  v_mfma_f32_16x16x32_bf16 v[68:71], v[148:151], v[228:231], v[68:71]
  v_mfma_f32_16x16x32_bf16 v[72:75], v[152:155], v[228:231], v[72:75]
  v_mfma_f32_16x16x32_bf16 v[76:79], v[156:159], v[228:231], v[76:79]
  s_waitcnt vmcnt(5)
  v_mfma_f32_16x16x32_bf16 v[64:67], v[160:163], v[232:235], v[64:67]
  v_mfma_f32_16x16x32_bf16 v[68:71], v[164:167], v[232:235], v[68:71]
  v_mfma_f32_16x16x32_bf16 v[72:75], v[168:171], v[232:235], v[72:75]
  v_mfma_f32_16x16x32_bf16 v[76:79], v[172:175], v[232:235], v[76:79]
  s_waitcnt vmcnt(4)
  v_mfma_f32_16x16x32_bf16 v[64:67], v[176:179], v[236:239], v[64:67]
  v_mfma_f32_16x16x32_bf16 v[68:71], v[180:183], v[236:239], v[68:71]
  v_mfma_f32_16x16x32_bf16 v[72:75], v[184:187], v[236:239], v[72:75]
  v_mfma_f32_16x16x32_bf16 v[76:79], v[188:191], v[236:239], v[76:79]
  s_waitcnt vmcnt(3)
  v_mfma_f32_16x16x32_bf16 v[80:83], v[128:131], v[48:51], v[80:83]
  v_mfma_f32_16x16x32_bf16 v[84:87], v[136:139], v[48:51], v[84:87]
  v_mfma_f32_16x16x32_bf16 v[88:91], v[140:143], v[48:51], v[88:91]
  v_mfma_f32_16x16x32_bf16 v[92:95], v[192:195], v[48:51], v[92:95]
  s_waitcnt vmcnt(2)
  v_mfma_f32_16x16x32_bf16 v[80:83], v[144:147], v[52:55], v[80:83]
  ds_write_b128 v27, v[64:67] offset:16384
  v_mfma_f32_16x16x32_bf16 v[84:87], v[148:151], v[52:55], v[84:87]
  ds_write_b128 v27, v[68:71] offset:20480
  v_mfma_f32_16x16x32_bf16 v[88:91], v[152:155], v[52:55], v[88:91]
  ds_write_b128 v27, v[72:75] offset:24576
  v_mfma_f32_16x16x32_bf16 v[92:95], v[156:159], v[52:55], v[92:95]
  ds_write_b128 v27, v[76:79] offset:28672
  s_waitcnt vmcnt(1)
  v_mfma_f32_16x16x32_bf16 v[80:83], v[160:163], v[56:59], v[80:83]
  s_mov_b64 exec, 1
  ds_add_u32 v10, v11 offset:116
  s_mov_b64 exec, -1
  v_mfma_f32_16x16x32_bf16 v[84:87], v[164:167], v[56:59], v[84:87]
  v_mfma_f32_16x16x32_bf16 v[88:91], v[168:171], v[56:59], v[88:91]
  v_mfma_f32_16x16x32_bf16 v[92:95], v[172:175], v[56:59], v[92:95]
  s_waitcnt vmcnt(0)
  v_mfma_f32_16x16x32_bf16 v[80:83], v[176:179], v[60:63], v[80:83]
  v_mfma_f32_16x16x32_bf16 v[84:87], v[180:183], v[60:63], v[84:87]
  v_mfma_f32_16x16x32_bf16 v[88:91], v[184:187], v[60:63], v[88:91]
  v_mfma_f32_16x16x32_bf16 v[92:95], v[188:191], v[60:63], v[92:95]
  s_nop 7
  ds_write_b128 v27, v[80:83] offset:32768
  ds_write_b128 v27, v[84:87] offset:36864
  ds_write_b128 v27, v[88:91] offset:40960
  ds_write_b128 v27, v[92:95] offset:45056
  s_mov_b64 exec, 1
  ds_add_u32 v10, v11 offset:124
  s_mov_b64 exec, -1
  s_endpgm
L_helper:
  s_setprio 3
  v_lshrrev_b32 v2, 3, v1
  v_and_b32 v3, 7, v1
  v_lshlrev_b32 v4, 10, v2
  v_lshl_add_u32 v4, v3, 4, v4
  s_lshl_b32 s3, s10, 16
  s_lshl_b32 s4, s9, 7
  s_add_u32 s3, s3, s4
  s_sub_u32 s3, s3, 8192
  v_add_u32 v72, s3, v4
  s_add_u32 s4, s8, 1
  s_lshl_b32 s7, s4, 4
  v_xor_b32 v5, s7, v4
  s_lshl_b32 s4, s4, 13
  s_add_u32 s4, s4, s3
  v_add_u32 v70, s4, v5
  s_add_u32 s7, s8, 5
  s_and_b32 s7, s7, 7
  s_lshl_b32 s7, s7, 4
  v_xor_b32 v5, s7, v4
  s_add_u32 s4, s4, 32768
  v_add_u32 v71, s4, v5
  s_lshl_b32 s3, s9, 6
  s_lshl_b32 s4, s8, 4
  s_add_u32 s3, s3, s4
  v_lshl_add_u32 v4, v2, 1, s3
  v_lshlrev_b32 v113, 3, v4
  v_and_b32 v2, 15, v1
  v_min_u32 v2, 13, v2
  v_lshlrev_b32 v2, 7, v2
  v_lshrrev_b32 v3, 4, v1
  s_mov_b32 s3, 458752
  v_mad_u32_u24 v117, v3, s3, v2
  s_mul_i32 s3, s6, 3584
  s_and_b32 s4, s9, 1
  s_mul_i32 s4, s4, 1792
  s_add_u32 s3, s3, s4
  v_add_u32 v117, s3, v117
  v_bfe_u32 v2, v1, 1, 2
  v_lshlrev_b32 v2, 10, v2
  v_and_b32 v4, 1, v1
  v_lshl_add_u32 v2, v4, 7, v2
  v_bfe_u32 v4, v1, 3, 2
  v_lshl_add_u32 v118, v4, 8, v2
  s_lshl_b32 s3, s6, 12
  s_lshr_b32 s4, s9, 1
  s_lshl_b32 s4, s4, 19
  s_add_u32 s3, s3, s4
  v_add_u32 v118, s3, v118
  v_lshrrev_b32 v3, 3, v1
  v_and_b32 v4, 7, v1
  v_xor_b32 v4, v3, v4
  v_lshlrev_b32 v3, 10, v3
  v_lshl_add_u32 v86, v4, 4, v3
  v_lshrrev_b32 v4, 4, v1
  s_lshl_b32 s3, s14, 7
  s_lshl_b32 s4, s8, 5
  s_add_u32 s3, s3, s4
  v_lshl_add_u32 v87, v4, 3, s3
  s_waitcnt lgkmcnt(0)
  s_barrier
  s_or_b32 s3, s2, s8
  s_cmp_lg_u32 s3, 0
  s_cbranch_scc1 L_noep
  s_or_b32 s81, s81, 0x40000000
  v_mov_b32 v16, s80
  v_mov_b32 v17, s81
  s_mov_b64 exec, 1
  global_store_dwordx2 v9, v[16:17], s[40:41] sc1
  s_mov_b64 exec, -1
L_noep:
  s_mov_b32 s56, s18
  s_and_b32 s57, s19, 0xffff
  s_mov_b32 s58, 0x200000
  s_mov_b32 s59, 0x20000
  s_mov_b32 s60, s20
  s_and_b32 s61, s21, 0xffff
  s_mov_b32 s62, 0x200000
  s_mov_b32 s63, 0x20000
  s_cmp_lg_u32 s8, 0
  s_cbranch_scc1 L_nok0
  s_mov_b32 m0, 124160
  s_nop 0
  buffer_load_dwordx4 v72, s[56:59], 0 offen lds
L_nok0:
  s_lshl_b32 s3, s8, 10
  s_add_u32 m0, s3, 125184
  s_nop 0
  buffer_load_dwordx4 v70, s[56:59], 0 offen lds
  s_add_u32 m0, s3, 129280
  s_nop 0
  buffer_load_dwordx4 v71, s[56:59], 0 offen lds
  s_add_u32 m0, s3, 133376
  s_nop 0
  buffer_load_dwordx4 v70, s[60:63], 0 offen lds
  s_add_u32 m0, s3, 137472
  s_nop 0
  buffer_load_dwordx4 v71, s[60:63], 0 offen lds
  global_load_dwordx4 v[64:67], v113, s[22:23]
  s_setprio 2
  s_mov_b32 s48, s30
  s_and_b32 s49, s31, 0xffff
  s_mov_b32 s50, 0x1c0000
  s_mov_b32 s51, 0x20000
  s_mov_b32 s44, s16
  s_and_b32 s45, s17, 0xffff
  s_mov_b32 s46, 0x200000
  s_mov_b32 s47, 0x20000
  s_mov_b32 s30, 600000
  s_lshl_b32 s3, s13, 16
  s_lshl_b32 s4, s8, 14
  s_add_u32 s3, s3, s4
  s_lshl_b32 s4, s14, 7
  s_add_u32 s3, s3, s4
  s_lshl_b32 s4, s8, 11
  s_add_u32 m0, s4, 141568
  s_nop 0
  buffer_load_dwordx4 v86, s[44:47], s3 offen lds
  s_add_u32 m0, s4, 142592
  s_add_u32 s3, s3, 0x2000
  buffer_load_dwordx4 v86, s[44:47], s3 offen lds
  global_load_dwordx2 v[248:249], v87, s[36:37]
  s_mov_b32 exec_lo, 0x3fff0000
  s_mov_b32 exec_hi, 0x3fff
  buffer_load_dword v20, v117, s[48:51], 0 offen
  s_mov_b32 exec_lo, 0xffff00
  s_mov_b32 exec_hi, 0
  buffer_load_dword v20, v118, s[44:47], 0 offen
  s_mov_b64 exec, -1
  s_mov_b32 s3, 1198373
  s_mov_b32 s4, 3360
  s_mov_b32 s97, 14336
  v_lshlrev_b32 v2, 8, v1
  v_lshlrev_b32 v6, 4, v1
  v_mul_hi_u32_u24 v3, s3, v2
  v_mad_u32_u24 v34, v3, s4, v6
  v_bfe_u32 v4, v3, 2, 1
  v_bfe_u32 v5, v3, 3, 1
  v_sub_u32 v4, v4, v5
  v_mad_i32_i24 v34, v4, s97, v34
  v_add_u32 v2, 0x4000, v2
  v_mul_hi_u32_u24 v3, s3, v2
  v_mad_u32_u24 v35, v3, s4, v6
  v_bfe_u32 v4, v3, 2, 1
  v_bfe_u32 v5, v3, 3, 1
  v_sub_u32 v4, v4, v5
  v_mad_i32_i24 v35, v4, s97, v35
  v_add_u32 v2, 0x4000, v2
  v_mul_hi_u32_u24 v3, s3, v2
  v_mad_u32_u24 v36, v3, s4, v6
  v_bfe_u32 v4, v3, 2, 1
  v_bfe_u32 v5, v3, 3, 1
  v_sub_u32 v4, v4, v5
  v_mad_i32_i24 v36, v4, s97, v36
  v_add_u32 v2, 0x4000, v2
  v_mul_hi_u32_u24 v3, s3, v2
  v_mad_u32_u24 v37, v3, s4, v6
  v_bfe_u32 v4, v3, 2, 1
  v_bfe_u32 v5, v3, 3, 1
  v_sub_u32 v4, v4, v5
  v_mad_i32_i24 v37, v4, s97, v37
  v_add_u32 v6, 0x1000, v6
  v_add_u32 v2, 0x4000, v2
  v_mul_hi_u32_u24 v3, s3, v2
  v_mad_u32_u24 v38, v3, s4, v6
  v_bfe_u32 v4, v3, 2, 1
  v_bfe_u32 v5, v3, 3, 1
  v_sub_u32 v4, v4, v5
  v_mad_i32_i24 v38, v4, s97, v38
  v_add_u32 v2, 0x4000, v2
  v_mul_hi_u32_u24 v3, s3, v2
  v_mad_u32_u24 v39, v3, s4, v6
  v_bfe_u32 v4, v3, 2, 1
  v_bfe_u32 v5, v3, 3, 1
  v_sub_u32 v4, v4, v5
  v_mad_i32_i24 v39, v4, s97, v39
  v_add_u32 v2, 0x4000, v2
  v_mul_hi_u32_u24 v3, s3, v2
  v_mad_u32_u24 v40, v3, s4, v6
  v_bfe_u32 v4, v3, 2, 1
  v_bfe_u32 v5, v3, 3, 1
  v_sub_u32 v4, v4, v5
  v_mad_i32_i24 v40, v4, s97, v40
  s_mul_i32 s84, s12, 224
  s_mul_i32 s3, s8, 114688
  s_add_u32 s84, s84, s3
  s_mul_i32 s85, s8, 7168
  s_mov_b32 s52, s42
  s_and_b32 s53, s43, 0xffff
  s_mov_b32 s54, 0x10000000
  s_mov_b32 s55, 0x20000
  s_mov_b32 s72, s34
  s_and_b32 s73, s35, 0xffff
  s_mov_b32 s74, 0x1c0000
  s_mov_b32 s75, 0x20000
  v_lshrrev_b32 v2, 3, v1
  v_and_b32 v3, 7, v1
  s_lshl_b32 s3, s9, 6
  s_lshl_b32 s4, s8, 4
  s_add_u32 s3, s3, s4
  v_lshl_add_u32 v4, v2, 1, s3
  v_lshlrev_b32 v113, 3, v4
  v_lshlrev_b32 v68, 12, v4
  v_lshl_add_u32 v68, v3, 4, v68
  s_lshl_b32 s3, s10, 7
  s_sub_u32 s3, 3968, s3
  v_add_u32 v68, s3, v68
  v_sub_u32 v4, 7, v3
  v_lshrrev_b32 v3, 2, v2
  s_lshl_b32 s3, s8, 1
  v_add_u32 v3, s3, v3
  v_and_b32 v2, 3, v2
  v_lshlrev_b32 v2, 2, v2
  v_lshl_add_u32 v2, v4, 10, v2
  v_xor_b32 v5, v3, v4
  v_lshl_add_u32 v5, v5, 4, v2
  v_add_u32 v74, 124160, v5
  v_add_u32 v4, 1, v4
  v_and_b32 v4, 7, v4
  v_xor_b32 v5, v3, v4
  v_lshl_add_u32 v5, v5, 4, v2
  v_add_u32 v75, 125184, v5
  v_add_u32 v76, 133376, v5
  s_lshr_b32 s3, s8, 1
  s_lshl_b32 s4, s9, 6
  s_add_u32 s3, s3, s4
  s_lshl_b32 s4, s10, 1
  s_add_u32 s101, s3, s4
  s_lshl_b32 s3, s101, 12
  s_add_u32 s64, s24, s3
  s_addc_u32 s65, s25, 0
  s_and_b32 s65, s65, 0xffff
  s_mov_b32 s66, 0x1000
  s_mov_b32 s67, 0x20000
  s_add_u32 s68, s42, s3
  s_addc_u32 s69, s43, 0
  s_and_b32 s69, s69, 0xffff
  s_mov_b32 s70, 0x1000
  s_mov_b32 s71, 0x20000
  s_mov_b32 s76, s38
  s_and_b32 s77, s39, 0xffff
  s_mov_b32 s78, 0x200000
  s_mov_b32 s79, 0x20000
  v_and_b32 v4, 7, v1
  v_lshlrev_b32 v4, 1, v4
  v_bfe_u32 v5, v1, 3, 1
  v_or_b32 v4, v4, v5
  v_and_b32 v5, 48, v1
  s_lshl_b32 s3, s5, 6
  v_add3_u32 v4, v4, v5, s3
  v_lshlrev_b32 v114, 4, v4
  v_subrev_u32 v115, 8, v114
  s_lshl_b32 s3, s101, 1
  v_mov_b32 v116, s3
  v_bfe_u32 v5, v4, 1, 2
  v_mul_u32_u24 v5, 289, v5
  v_and_b32 v3, 1, v4
  s_mov_b32 s3, 144
  v_mad_u32_u24 v5, v3, s3, v5
  v_lshrrev_b32 v3, 3, v4
  v_lshl_add_u32 v5, v3, 2, v5
  s_lshr_b32 s3, s8, 1
  s_mul_i32 s86, s3, 18496
  s_add_u32 s86, s86, 126848
  s_mul_i32 s87, s3, 8448
  s_add_u32 s87, s87, 28672
  v_lshl_add_u32 v19, v5, 4, s86
  v_lshrrev_b32 v18, 2, v1
  v_lshlrev_b32 v18, 7, v18
  s_lshl_b32 s6, s6, 11
  v_lshrrev_b32 v4, 4, v1
  v_and_b32 v3, 15, v1
  v_lshrrev_b32 v5, 1, v4
  s_lshl_b32 s3, s8, 1
  v_add_u32 v5, s3, v5
  v_and_b32 v6, 7, v3
  v_xor_b32 v5, v6, v5
  v_lshlrev_b32 v3, 7, v3
  v_lshl_add_u32 v3, v5, 4, v3
  v_and_b32 v4, 1, v4
  v_lshl_add_u32 v3, v4, 3, v3
  v_add_u32 v107, 141568, v3
  s_waitcnt vmcnt(2)
  s_mov_b64 exec, 1
  ds_add_u32 v10, v11 offset:48
  s_mov_b64 exec, -1
  s_mov_b32 exec_lo, 0x0
  s_mov_b32 exec_hi, 0x3fff0000
  buffer_load_dword v20, v117, s[48:51], 0 offen
  s_mov_b32 exec_lo, 0xff000000
  s_mov_b32 exec_hi, 0
  buffer_load_dword v20, v118, s[44:47], 0 offen
  s_mov_b64 exec, -1
Lh1:
  ds_read_b32 v8, v10 offset:48
  s_waitcnt lgkmcnt(0)
  v_cmp_gt_u32 vcc, 4, v8
  s_cbranch_vccz Lh1_x
  s_sleep 1
  s_sub_u32 s30, s30, 1
  s_cmp_gt_i32 s30, 0
  s_cbranch_scc1 Lh1
Lh1_x:
  s_setprio 1
  ds_read_b64 v[240:241], v107 offset:0
  ds_read_b64 v[242:243], v107 offset:2048
  ds_read_b64 v[244:245], v107 offset:4096
  ds_read_b64 v[246:247], v107 offset:6144
  ds_read2_b32 v[44:45], v74 offset0:160 offset1:192
  ds_read_b32 v46, v74 offset:896
  ds_read2_b32 v[48:49], v75 offset0:0 offset1:32
  ds_read2_b32 v[50:51], v75 offset0:64 offset1:96
  ds_read2_b32 v[52:53], v75 offset0:128 offset1:160
  ds_read2_b32 v[54:55], v75 offset0:192 offset1:224
  ds_read2_b32 v[56:57], v76 offset0:0 offset1:32
  ds_read2_b32 v[58:59], v76 offset0:64 offset1:96
  ds_read2_b32 v[60:61], v76 offset0:128 offset1:160
  ds_read2_b32 v[62:63], v76 offset0:192 offset1:224
  v_lshlrev_b32 v78, 16, v64
  v_lshlrev_b32 v79, 16, v66
  v_and_b32 v80, s15, v64
  v_and_b32 v81, s15, v66
  v_lshlrev_b32 v82, 16, v65
  v_lshlrev_b32 v83, 16, v67
  v_and_b32 v84, s15, v65
  v_and_b32 v85, s15, v67
  s_waitcnt lgkmcnt(0)
  s_mov_b64 exec, 1
  ds_add_u32 v10, v11 offset:52
  s_mov_b64 exec, -1
  v_lshlrev_b32 v86, 16, v44
  v_and_b32 v87, s15, v44
  v_lshlrev_b32 v88, 16, v45
  v_and_b32 v89, s15, v45
  v_lshlrev_b32 v90, 16, v46
  v_and_b32 v91, s15, v46
  v_lshlrev_b32 v92, 16, v48
  v_and_b32 v93, s15, v48
  v_lshlrev_b32 v94, 16, v49
  v_and_b32 v95, s15, v49
  v_lshlrev_b32 v96, 16, v50
  v_and_b32 v97, s15, v50
  v_lshlrev_b32 v98, 16, v51
  v_and_b32 v99, s15, v51
  v_lshlrev_b32 v100, 16, v52
  v_and_b32 v101, s15, v52
  v_lshlrev_b32 v102, 16, v53
  v_and_b32 v103, s15, v53
  v_lshlrev_b32 v104, 16, v54
  v_and_b32 v105, s15, v54
  v_lshlrev_b32 v106, 16, v55
  v_and_b32 v107, s15, v55
  v_mul_f32 v86, v86, v84
  v_mul_f32 v87, v87, v85
  v_cvt_pk_bf16_f32 v112, v86, v87
  v_lshlrev_b32 v86, 16, v112
  v_and_b32 v87, s15, v112
  v_mul_f32 v108, v88, v82
  v_mul_f32 v109, v89, v83
  v_cvt_pk_bf16_f32 v112, v108, v109
  v_lshlrev_b32 v108, 16, v112
  v_and_b32 v109, s15, v112
  v_add_f32 v86, v86, v108
  v_add_f32 v87, v87, v109
  v_cvt_pk_bf16_f32 v112, v86, v87
  v_lshlrev_b32 v86, 16, v112
  v_and_b32 v87, s15, v112
  v_mul_f32 v108, v90, v80
  v_mul_f32 v109, v91, v81
  v_cvt_pk_bf16_f32 v112, v108, v109
  v_lshlrev_b32 v108, 16, v112
  v_and_b32 v109, s15, v112
  v_add_f32 v86, v86, v108
  v_add_f32 v87, v87, v109
  v_cvt_pk_bf16_f32 v112, v86, v87
  v_lshlrev_b32 v86, 16, v112
  v_and_b32 v87, s15, v112
  v_mul_f32 v108, v92, v78
  v_mul_f32 v109, v93, v79
  v_cvt_pk_bf16_f32 v112, v108, v109
  v_lshlrev_b32 v108, 16, v112
  v_and_b32 v109, s15, v112
  v_add_f32 v86, v86, v108
  v_add_f32 v87, v87, v109
  v_cvt_pk_bf16_f32 v112, v86, v87
  v_lshlrev_b32 v86, 16, v112
  v_and_b32 v87, s15, v112
  v_lshlrev_b32 v110, 16, v56
  v_and_b32 v111, s15, v56
  v_mul_f32 v86, v86, v110
  v_mul_f32 v87, v87, v111
  v_mul_f32 v88, v88, v84
  v_mul_f32 v89, v89, v85
  v_cvt_pk_bf16_f32 v112, v88, v89
  v_lshlrev_b32 v88, 16, v112
  v_and_b32 v89, s15, v112
  v_mul_f32 v108, v90, v82
  v_mul_f32 v109, v91, v83
  v_cvt_pk_bf16_f32 v112, v108, v109
  v_lshlrev_b32 v108, 16, v112
  v_and_b32 v109, s15, v112
  v_add_f32 v88, v88, v108
  v_add_f32 v89, v89, v109
  v_cvt_pk_bf16_f32 v112, v88, v89
  v_lshlrev_b32 v88, 16, v112
  v_and_b32 v89, s15, v112
  v_mul_f32 v108, v92, v80
  v_mul_f32 v109, v93, v81
  v_cvt_pk_bf16_f32 v112, v108, v109
  v_lshlrev_b32 v108, 16, v112
  v_and_b32 v109, s15, v112
  v_add_f32 v88, v88, v108
  v_add_f32 v89, v89, v109
  v_cvt_pk_bf16_f32 v112, v88, v89
  v_lshlrev_b32 v88, 16, v112
  v_and_b32 v89, s15, v112
  v_mul_f32 v108, v94, v78
  v_mul_f32 v109, v95, v79
  v_cvt_pk_bf16_f32 v112, v108, v109
  v_lshlrev_b32 v108, 16, v112
  v_and_b32 v109, s15, v112
  v_add_f32 v88, v88, v108
  v_add_f32 v89, v89, v109
  v_cvt_pk_bf16_f32 v112, v88, v89
  v_lshlrev_b32 v88, 16, v112
  v_and_b32 v89, s15, v112
  v_lshlrev_b32 v110, 16, v57
  v_and_b32 v111, s15, v57
  v_mul_f32 v88, v88, v110
  v_mul_f32 v89, v89, v111
  v_mul_f32 v90, v90, v84
  v_mul_f32 v91, v91, v85
  v_cvt_pk_bf16_f32 v112, v90, v91
  v_lshlrev_b32 v90, 16, v112
  v_and_b32 v91, s15, v112
  v_mul_f32 v108, v92, v82
  v_mul_f32 v109, v93, v83
  v_cvt_pk_bf16_f32 v112, v108, v109
  v_lshlrev_b32 v108, 16, v112
  v_and_b32 v109, s15, v112
  v_add_f32 v90, v90, v108
  v_add_f32 v91, v91, v109
  v_cvt_pk_bf16_f32 v112, v90, v91
  v_lshlrev_b32 v90, 16, v112
  v_and_b32 v91, s15, v112
  v_mul_f32 v108, v94, v80
  v_mul_f32 v109, v95, v81
  v_cvt_pk_bf16_f32 v112, v108, v109
  v_lshlrev_b32 v108, 16, v112
  v_and_b32 v109, s15, v112
  v_add_f32 v90, v90, v108
  v_add_f32 v91, v91, v109
  v_cvt_pk_bf16_f32 v112, v90, v91
  v_lshlrev_b32 v90, 16, v112
  v_and_b32 v91, s15, v112
  v_mul_f32 v108, v96, v78
  v_mul_f32 v109, v97, v79
  v_cvt_pk_bf16_f32 v112, v108, v109
  v_lshlrev_b32 v108, 16, v112
  v_and_b32 v109, s15, v112
  v_add_f32 v90, v90, v108
  v_add_f32 v91, v91, v109
  v_cvt_pk_bf16_f32 v112, v90, v91
  v_lshlrev_b32 v90, 16, v112
  v_and_b32 v91, s15, v112
  v_lshlrev_b32 v110, 16, v58
  v_and_b32 v111, s15, v58
  v_mul_f32 v90, v90, v110
  v_mul_f32 v91, v91, v111
  v_mul_f32 v92, v92, v84
  v_mul_f32 v93, v93, v85
  v_cvt_pk_bf16_f32 v112, v92, v93
  v_lshlrev_b32 v92, 16, v112
  v_and_b32 v93, s15, v112
  v_mul_f32 v108, v94, v82
  v_mul_f32 v109, v95, v83
  v_cvt_pk_bf16_f32 v112, v108, v109
  v_lshlrev_b32 v108, 16, v112
  v_and_b32 v109, s15, v112
  v_add_f32 v92, v92, v108
  v_add_f32 v93, v93, v109
  v_cvt_pk_bf16_f32 v112, v92, v93
  v_lshlrev_b32 v92, 16, v112
  v_and_b32 v93, s15, v112
  v_mul_f32 v108, v96, v80
  v_mul_f32 v109, v97, v81
  v_cvt_pk_bf16_f32 v112, v108, v109
  v_lshlrev_b32 v108, 16, v112
  v_and_b32 v109, s15, v112
  v_add_f32 v92, v92, v108
  v_add_f32 v93, v93, v109
  v_cvt_pk_bf16_f32 v112, v92, v93
  v_lshlrev_b32 v92, 16, v112
  v_and_b32 v93, s15, v112
  v_mul_f32 v108, v98, v78
  v_mul_f32 v109, v99, v79
  v_cvt_pk_bf16_f32 v112, v108, v109
  v_lshlrev_b32 v108, 16, v112
  v_and_b32 v109, s15, v112
  v_add_f32 v92, v92, v108
  v_add_f32 v93, v93, v109
  v_cvt_pk_bf16_f32 v112, v92, v93
  v_lshlrev_b32 v92, 16, v112
  v_and_b32 v93, s15, v112
  v_lshlrev_b32 v110, 16, v59
  v_and_b32 v111, s15, v59
  v_mul_f32 v92, v92, v110
  v_mul_f32 v93, v93, v111
  v_mul_f32 v94, v94, v84
  v_mul_f32 v95, v95, v85
  v_cvt_pk_bf16_f32 v112, v94, v95
  v_lshlrev_b32 v94, 16, v112
  v_and_b32 v95, s15, v112
  v_mul_f32 v108, v96, v82
  v_mul_f32 v109, v97, v83
  v_cvt_pk_bf16_f32 v112, v108, v109
  v_lshlrev_b32 v108, 16, v112
  v_and_b32 v109, s15, v112
  v_add_f32 v94, v94, v108
  v_add_f32 v95, v95, v109
  v_cvt_pk_bf16_f32 v112, v94, v95
  v_lshlrev_b32 v94, 16, v112
  v_and_b32 v95, s15, v112
  v_mul_f32 v108, v98, v80
  v_mul_f32 v109, v99, v81
  v_cvt_pk_bf16_f32 v112, v108, v109
  v_lshlrev_b32 v108, 16, v112
  v_and_b32 v109, s15, v112
  v_add_f32 v94, v94, v108
  v_add_f32 v95, v95, v109
  v_cvt_pk_bf16_f32 v112, v94, v95
  v_lshlrev_b32 v94, 16, v112
  v_and_b32 v95, s15, v112
  v_mul_f32 v108, v100, v78
  v_mul_f32 v109, v101, v79
  v_cvt_pk_bf16_f32 v112, v108, v109
  v_lshlrev_b32 v108, 16, v112
  v_and_b32 v109, s15, v112
  v_add_f32 v94, v94, v108
  v_add_f32 v95, v95, v109
  v_cvt_pk_bf16_f32 v112, v94, v95
  v_lshlrev_b32 v94, 16, v112
  v_and_b32 v95, s15, v112
  v_lshlrev_b32 v110, 16, v60
  v_and_b32 v111, s15, v60
  v_mul_f32 v94, v94, v110
  v_mul_f32 v95, v95, v111
  v_mul_f32 v96, v96, v84
  v_mul_f32 v97, v97, v85
  v_cvt_pk_bf16_f32 v112, v96, v97
  v_lshlrev_b32 v96, 16, v112
  v_and_b32 v97, s15, v112
  v_mul_f32 v108, v98, v82
  v_mul_f32 v109, v99, v83
  v_cvt_pk_bf16_f32 v112, v108, v109
  v_lshlrev_b32 v108, 16, v112
  v_and_b32 v109, s15, v112
  v_add_f32 v96, v96, v108
  v_add_f32 v97, v97, v109
  v_cvt_pk_bf16_f32 v112, v96, v97
  v_lshlrev_b32 v96, 16, v112
  v_and_b32 v97, s15, v112
  v_mul_f32 v108, v100, v80
  v_mul_f32 v109, v101, v81
  v_cvt_pk_bf16_f32 v112, v108, v109
  v_lshlrev_b32 v108, 16, v112
  v_and_b32 v109, s15, v112
  v_add_f32 v96, v96, v108
  v_add_f32 v97, v97, v109
  v_cvt_pk_bf16_f32 v112, v96, v97
  v_lshlrev_b32 v96, 16, v112
  v_and_b32 v97, s15, v112
  v_mul_f32 v108, v102, v78
  v_mul_f32 v109, v103, v79
  v_cvt_pk_bf16_f32 v112, v108, v109
  v_lshlrev_b32 v108, 16, v112
  v_and_b32 v109, s15, v112
  v_add_f32 v96, v96, v108
  v_add_f32 v97, v97, v109
  v_cvt_pk_bf16_f32 v112, v96, v97
  v_lshlrev_b32 v96, 16, v112
  v_and_b32 v97, s15, v112
  v_lshlrev_b32 v110, 16, v61
  v_and_b32 v111, s15, v61
  v_mul_f32 v96, v96, v110
  v_mul_f32 v97, v97, v111
  global_load_dwordx2 v[16:17], v9, s[40:41] sc1
  v_mul_f32 v98, v98, v84
  v_mul_f32 v99, v99, v85
  v_cvt_pk_bf16_f32 v112, v98, v99
  v_lshlrev_b32 v98, 16, v112
  v_and_b32 v99, s15, v112
  v_mul_f32 v108, v100, v82
  v_mul_f32 v109, v101, v83
  v_cvt_pk_bf16_f32 v112, v108, v109
  v_lshlrev_b32 v108, 16, v112
  v_and_b32 v109, s15, v112
  v_add_f32 v98, v98, v108
  v_add_f32 v99, v99, v109
  v_cvt_pk_bf16_f32 v112, v98, v99
  v_lshlrev_b32 v98, 16, v112
  v_and_b32 v99, s15, v112
  v_mul_f32 v108, v102, v80
  v_mul_f32 v109, v103, v81
  v_cvt_pk_bf16_f32 v112, v108, v109
  v_lshlrev_b32 v108, 16, v112
  v_and_b32 v109, s15, v112
  v_add_f32 v98, v98, v108
  v_add_f32 v99, v99, v109
  v_cvt_pk_bf16_f32 v112, v98, v99
  v_lshlrev_b32 v98, 16, v112
  v_and_b32 v99, s15, v112
  v_mul_f32 v108, v104, v78
  v_mul_f32 v109, v105, v79
  v_cvt_pk_bf16_f32 v112, v108, v109
  v_lshlrev_b32 v108, 16, v112
  v_and_b32 v109, s15, v112
  v_add_f32 v98, v98, v108
  v_add_f32 v99, v99, v109
  v_cvt_pk_bf16_f32 v112, v98, v99
  v_lshlrev_b32 v98, 16, v112
  v_and_b32 v99, s15, v112
  v_lshlrev_b32 v110, 16, v62
  v_and_b32 v111, s15, v62
  v_mul_f32 v98, v98, v110
  v_mul_f32 v99, v99, v111
  v_mul_f32 v100, v100, v84
  v_mul_f32 v101, v101, v85
  v_cvt_pk_bf16_f32 v112, v100, v101
  v_lshlrev_b32 v100, 16, v112
  v_and_b32 v101, s15, v112
  v_mul_f32 v108, v102, v82
  v_mul_f32 v109, v103, v83
  v_cvt_pk_bf16_f32 v112, v108, v109
  v_lshlrev_b32 v108, 16, v112
  v_and_b32 v109, s15, v112
  v_add_f32 v100, v100, v108
  v_add_f32 v101, v101, v109
  v_cvt_pk_bf16_f32 v112, v100, v101
  v_lshlrev_b32 v100, 16, v112
  v_and_b32 v101, s15, v112
  v_mul_f32 v108, v104, v80
  v_mul_f32 v109, v105, v81
  v_cvt_pk_bf16_f32 v112, v108, v109
  v_lshlrev_b32 v108, 16, v112
  v_and_b32 v109, s15, v112
  v_add_f32 v100, v100, v108
  v_add_f32 v101, v101, v109
  v_cvt_pk_bf16_f32 v112, v100, v101
  v_lshlrev_b32 v100, 16, v112
  v_and_b32 v101, s15, v112
  v_mul_f32 v108, v106, v78
  v_mul_f32 v109, v107, v79
  v_cvt_pk_bf16_f32 v112, v108, v109
  v_lshlrev_b32 v108, 16, v112
  v_and_b32 v109, s15, v112
  v_add_f32 v100, v100, v108
  v_add_f32 v101, v101, v109
  v_cvt_pk_bf16_f32 v112, v100, v101
  v_lshlrev_b32 v100, 16, v112
  v_and_b32 v101, s15, v112
  v_lshlrev_b32 v110, 16, v63
  v_and_b32 v111, s15, v63
  v_mul_f32 v100, v100, v110
  v_mul_f32 v101, v101, v111
  v_cvt_pk_bf16_f32 v44, v100, v98
  v_cvt_pk_bf16_f32 v45, v96, v94
  v_cvt_pk_bf16_f32 v46, v92, v90
  v_cvt_pk_bf16_f32 v47, v88, v86
  v_cvt_pk_bf16_f32 v48, v101, v99
  v_cvt_pk_bf16_f32 v49, v97, v95
  v_cvt_pk_bf16_f32 v50, v93, v91
  v_cvt_pk_bf16_f32 v51, v89, v87
  s_mov_b32 s3, 0x1000
  buffer_store_dwordx4 v[44:47], v68, s[52:55], 0 offen sc1
  buffer_store_dwordx4 v[48:51], v68, s[52:55], s3 offen sc1
  s_setprio 1
  s_lshl_b32 s97, s9, 10
  s_lshl_b32 s4, s8, 8
  s_add_u32 s28, s97, s4
  s_lshl_b32 s4, s10, 3
  s_add_u32 s28, s28, s4
  s_add_u32 s28, s28, 0xd04000
  s_lshr_b32 s3, s10, 3
  s_lshl_b32 s3, s3, 8
  s_add_u32 s97, s97, s3
  s_add_u32 s97, s97, 0xd04000
  s_waitcnt vmcnt(2)
  v_cmp_eq_u32 vcc, 0, v17
  s_cbranch_vccz Lh2_x
  s_mov_b32 s4, 0
Lh2:
  global_load_dwordx2 v[16:17], v9, s[40:41] sc1
  s_add_u32 s4, s4, 1
  s_waitcnt vmcnt(0)
  v_cmp_eq_u32 vcc, 0, v17
  s_cmp_ge_u32 s4, 30000
  s_cbranch_scc1 Lh2_x
  s_cbranch_vccnz Lh2
Lh2_x:
  s_waitcnt vmcnt(0)
  s_mov_b64 exec, 1
  buffer_store_dwordx2 v[16:17], v9, s[52:55], s28 offen sc1
  s_mov_b64 exec, -1
Lh3:
  ds_read_b32 v8, v10 offset:32
  s_waitcnt lgkmcnt(0)
  v_cmp_gt_u32 vcc, 4, v8
  s_cbranch_vccz Lh3_x
  s_sleep 1
  s_sub_u32 s30, s30, 1
  s_cmp_gt_i32 s30, 0
  s_cbranch_scc1 Lh3
Lh3_x:
  s_add_u32 m0, s85, 0
  s_add_u32 s29, s84, 1376256
  buffer_load_dwordx4 v34, s[48:51], s29 offen offset:0 lds
  buffer_load_dwordx4 v35, s[48:51], s29 offen offset:1024 lds
  buffer_load_dwordx4 v36, s[48:51], s29 offen offset:2048 lds
  buffer_load_dwordx4 v37, s[48:51], s29 offen offset:3072 lds
  s_add_u32 m0, s85, 4096
  s_add_u32 s29, s84, 1376256
  buffer_load_dwordx4 v38, s[48:51], s29 offen offset:0 lds
  buffer_load_dwordx4 v39, s[48:51], s29 offen offset:1024 lds
  buffer_load_dwordx4 v40, s[48:51], s29 offen offset:2048 lds
  buffer_load_dwordx2 v[22:23], v115, s[64:67], 0 offen
  buffer_load_dwordx4 v[24:27], v114, s[64:67], 0 offen
  buffer_load_dwordx2 v[28:29], v114, s[64:67], 0 offen offset:2040
  buffer_load_dwordx4 v[30:33], v114, s[64:67], 0 offen offset:2048
  global_load_ushort v20, v116, s[26:27]
  s_waitcnt vmcnt(5)
  s_mov_b64 exec, 1
  ds_add_u32 v10, v11 offset:12
  s_mov_b64 exec, -1
  s_add_u32 s3, s6, 0
  buffer_load_dword v255, v18, s[72:75], s3 offen
  s_add_u32 s3, s6, 262144
  buffer_load_dword v255, v18, s[72:75], s3 offen
  s_add_u32 s3, s6, 524288
  buffer_load_dword v255, v18, s[72:75], s3 offen
  s_add_u32 s3, s6, 786432
  buffer_load_dword v255, v18, s[72:75], s3 offen
  v_mov_b32 v104, 0
  v_mov_b32 v105, 0
  v_mov_b32 v106, 0
  v_mov_b32 v107, 0
  s_lshl_b32 s3, s5, 6
  v_add_u32 v3, s3, v1
  s_mov_b32 s3, 5462
  v_mul_u32_u24 v4, s3, v3
  v_lshrrev_b32 v4, 16, v4
  v_mul_u32_u24 v5, 12, v4
  v_sub_u32 v5, v3, v5
  v_lshrrev_b32 v2, 1, v4
  s_mov_b32 s3, 289
  v_mad_u32_u24 v5, v2, s3, v5
  v_and_b32 v4, 1, v4
  s_mov_b32 s3, 144
  v_mad_u32_u24 v5, v4, s3, v5
  v_lshl_add_u32 v43, v5, 4, s86
  v_lshrrev_b32 v2, 5, v1
  v_mul_u32_u24 v2, 289, v2
  v_bfe_u32 v3, v1, 4, 1
  v_mad_u32_u24 v2, v3, s3, v2
  v_and_b32 v3, 15, v1
  s_lshl_b32 s3, s5, 3
  v_add3_u32 v2, v3, v2, s3
  v_lshl_add_u32 v34, v2, 4, s86
  v_lshrrev_b32 v2, 4, v1
  v_lshlrev_b32 v2, 1, v2
  v_sub_u32 v2, v2, v3
  s_lshl_b32 s3, s5, 9
  s_add_u32 s3, s3, 240
  s_add_u32 s3, s3, s87
  v_lshl_add_u32 v35, v2, 4, s3
  s_lshl_b32 s3, s5, 10
  s_add_u32 s3, s3, s87
  v_lshl_add_u32 v39, v1, 4, s3
  v_and_b32 v38, 31, v1
  v_lshlrev_b32 v38, 3, v38
  s_lshr_b32 s3, s8, 1
  s_lshl_b32 s3, s3, 2
  v_add_u32 v42, s3, v10
Lh4:
  ds_read_b32 v8, v10 offset:52
  s_waitcnt lgkmcnt(0)
  v_cmp_gt_u32 vcc, 4, v8
  s_cbranch_vccz Lh4_x
  s_sleep 1
  s_sub_u32 s30, s30, 1
  s_cmp_gt_i32 s30, 0
  s_cbranch_scc1 Lh4
Lh4_x:
  s_cmp_eq_u32 s5, 0
  s_cselect_b32 exec_hi, -1, 0
  ds_write_b128 v43, v[104:107]
  s_mov_b64 exec, -1
  s_waitcnt vmcnt(4)
  v_alignbit_b32 v80, v23, v22, 16
  v_alignbit_b32 v81, v24, v23, 16
  v_alignbit_b32 v82, v25, v24, 16
  v_alignbit_b32 v83, v26, v25, 16
  ds_write_b128 v19, v[24:27] offset:240
  v_mov_b32 v84, v23
  v_mov_b32 v85, v24
  v_mov_b32 v86, v25
  v_mov_b32 v87, v26
  ds_write_b128 v19, v[80:83] offset:192
  v_alignbit_b32 v88, v24, v23, 16
  v_alignbit_b32 v89, v25, v24, 16
  v_alignbit_b32 v90, v26, v25, 16
  v_alignbit_b32 v91, v27, v26, 16
  ds_write_b128 v19, v[84:87] offset:208
  ds_write_b128 v19, v[88:91] offset:224
  v_alignbit_b32 v92, v29, v28, 16
  v_alignbit_b32 v93, v30, v29, 16
  v_alignbit_b32 v94, v31, v30, 16
  v_alignbit_b32 v95, v32, v31, 16
  ds_write_b128 v19, v[30:33] offset:1264
  v_mov_b32 v96, v29
  v_mov_b32 v97, v30
  v_mov_b32 v98, v31
  v_mov_b32 v99, v32
  ds_write_b128 v19, v[92:95] offset:1216
  v_alignbit_b32 v100, v30, v29, 16
  v_alignbit_b32 v101, v31, v30, 16
  v_alignbit_b32 v102, v32, v31, 16
  v_alignbit_b32 v103, v33, v32, 16
  ds_write_b128 v19, v[96:99] offset:1232
  ds_write_b128 v19, v[100:103] offset:1248
  v_lshlrev_b32 v36, 16, v20
  v_lshlrev_b32 v37, 16, v20
  s_cmp_lg_u32 s8, 0
  s_cbranch_scc1 L_nokvp
  s_mov_b32 s4, 0
Lh5:
  buffer_load_dwordx2 v[40:41], v38, s[52:55], s97 offen sc1
  s_add_u32 s4, s4, 1
  s_waitcnt vmcnt(0)
  v_cmp_ne_u64 vcc, v[40:41], v[16:17]
  s_cmp_ge_u32 s4, 30000
  s_cbranch_scc1 Lh5_x
  s_cbranch_vccz Lh5_x
  s_sleep 2
  s_branch Lh5
Lh5_x:
  s_mov_b64 exec, 1
  ds_add_u32 v10, v11 offset:80
  s_mov_b64 exec, -1
L_nokvp:
Lh6:
  ds_read_b32 v8, v10 offset:80
  s_waitcnt lgkmcnt(0)
  v_cmp_gt_u32 vcc, 1, v8
  s_cbranch_vccz Lh6_x
  s_sleep 1
  s_sub_u32 s30, s30, 1
  s_cmp_gt_i32 s30, 0
  s_cbranch_scc1 Lh6
Lh6_x:
  s_lshl_b32 s3, s5, 9
  v_lshl_add_u32 v2, v1, 3, s3
  buffer_load_dwordx4 v[144:147], v2, s[68:71], 0 offen offset:0 sc1
  buffer_load_dwordx4 v[148:151], v2, s[68:71], 0 offen offset:1024 sc1
  buffer_load_dwordx4 v[152:155], v2, s[68:71], 0 offen offset:2048 sc1
  buffer_load_dwordx4 v[156:159], v2, s[68:71], 0 offen offset:3072 sc1
Lh7:
  ds_read_b32 v8, v10 offset:40
  s_waitcnt lgkmcnt(0)
  v_cmp_gt_u32 vcc, 4, v8
  s_cbranch_vccz Lh7_x
  s_sleep 1
  s_sub_u32 s30, s30, 1
  s_cmp_gt_i32 s30, 0
  s_cbranch_scc1 Lh7
Lh7_x:
  s_mov_b64 exec, 0xffff
  v_lshl_add_u32 v4, v1, 4, s87
  ds_write_b128 v4, v[104:107] offset:8192
  s_mov_b64 exec, -1
  s_waitcnt vmcnt(0)
  ds_write_b128 v39, v[144:147] offset:0
  ds_write_b128 v39, v[148:151] offset:2048
  ds_write_b128 v39, v[152:155] offset:4096
  ds_write_b128 v39, v[156:159] offset:6144
  s_mov_b64 exec, 1
  ds_add_u32 v42, v11 offset:56
  s_mov_b64 exec, -1
  s_add_u32 s3, s6, 1048576
  buffer_load_dword v255, v18, s[72:75], s3 offen
  s_add_u32 s3, s6, 1310720
  buffer_load_dword v255, v18, s[72:75], s3 offen
  s_add_u32 s3, s6, 1572864
  buffer_load_dword v255, v18, s[72:75], s3 offen
Lh8:
  ds_read_b32 v8, v42 offset:56
  s_waitcnt lgkmcnt(0)
  v_cmp_gt_u32 vcc, 2, v8
  s_cbranch_vccz Lh8_x
  s_sub_u32 s30, s30, 1
  s_cmp_gt_i32 s30, 0
  s_cbranch_scc1 Lh8
Lh8_x:
Lh9:
  ds_read_b32 v8, v10 offset:96
  s_waitcnt lgkmcnt(0)
  v_cmp_gt_u32 vcc, 4, v8
  s_cbranch_vccz Lh9_x
  s_sleep 1
  s_sub_u32 s30, s30, 1
  s_cmp_gt_i32 s30, 0
  s_cbranch_scc1 Lh9
Lh9_x:
  ds_read_b128 v[48:51], v34 offset:0
  ds_read_b128 v[112:115], v35 offset:7168
  ds_read_b128 v[116:119], v35 offset:6144
  ds_read_b128 v[120:123], v35 offset:5120
  ds_read_b128 v[124:127], v35 offset:4096
  ds_read_b128 v[128:131], v35 offset:3072
  ds_read_b128 v[132:135], v35 offset:2048
  ds_read_b128 v[136:139], v35 offset:1024
  ds_read_b128 v[140:143], v35 offset:0
  ds_read_b128 v[52:55], v34 offset:256
  ds_read_b128 v[56:59], v34 offset:512
  ds_read_b128 v[60:63], v34 offset:768
  ds_read_b128 v[64:67], v34 offset:1024
  ds_read_b128 v[68:71], v34 offset:1280
  ds_read_b128 v[72:75], v34 offset:1536
  ds_read_b128 v[76:79], v34 offset:1792
  s_setprio 1
  s_waitcnt lgkmcnt(13)
  v_mfma_f32_16x16x32_bf16 v[176:179], v[48:51], v[112:115], 0
  v_mfma_f32_16x16x32_bf16 v[180:183], v[48:51], v[116:119], 0
  s_waitcnt lgkmcnt(10)
  v_mfma_f32_16x16x32_bf16 v[184:187], v[48:51], v[120:123], 0
  v_mfma_f32_16x16x32_bf16 v[188:191], v[48:51], v[124:127], 0
  v_mfma_f32_16x16x32_bf16 v[192:195], v[48:51], v[128:131], 0
  s_waitcnt lgkmcnt(7)
  v_mfma_f32_16x16x32_bf16 v[196:199], v[48:51], v[132:135], 0
  v_mfma_f32_16x16x32_bf16 v[200:203], v[48:51], v[136:139], 0
  v_mfma_f32_16x16x32_bf16 v[204:207], v[48:51], v[140:143], 0
  s_waitcnt lgkmcnt(0)
  v_mfma_f32_16x16x32_bf16 v[180:183], v[52:55], v[112:115], v[180:183]
  v_mfma_f32_16x16x32_bf16 v[184:187], v[52:55], v[116:119], v[184:187]
  ds_read_b128 v[80:83], v34 offset:9248
  v_mfma_f32_16x16x32_bf16 v[188:191], v[52:55], v[120:123], v[188:191]
  ds_read_b128 v[144:147], v35 offset:7296
  v_mfma_f32_16x16x32_bf16 v[192:195], v[52:55], v[124:127], v[192:195]
  ds_read_b128 v[148:151], v35 offset:6272
  v_mfma_f32_16x16x32_bf16 v[196:199], v[52:55], v[128:131], v[196:199]
  ds_read_b128 v[152:155], v35 offset:5248
  v_mfma_f32_16x16x32_bf16 v[200:203], v[52:55], v[132:135], v[200:203]
  ds_read_b128 v[156:159], v35 offset:4224
  v_mfma_f32_16x16x32_bf16 v[204:207], v[52:55], v[136:139], v[204:207]
  ds_read_b128 v[160:163], v35 offset:3200
  v_mfma_f32_16x16x32_bf16 v[184:187], v[56:59], v[112:115], v[184:187]
  ds_read_b128 v[164:167], v35 offset:2176
  v_mfma_f32_16x16x32_bf16 v[188:191], v[56:59], v[116:119], v[188:191]
  ds_read_b128 v[168:171], v35 offset:1152
  v_mfma_f32_16x16x32_bf16 v[192:195], v[56:59], v[120:123], v[192:195]
  ds_read_b128 v[172:175], v35 offset:128
  v_mfma_f32_16x16x32_bf16 v[196:199], v[56:59], v[124:127], v[196:199]
  ds_read_b128 v[84:87], v34 offset:9504
  v_mfma_f32_16x16x32_bf16 v[200:203], v[56:59], v[128:131], v[200:203]
  ds_read_b128 v[88:91], v34 offset:9760
  v_mfma_f32_16x16x32_bf16 v[204:207], v[56:59], v[132:135], v[204:207]
  ds_read_b128 v[92:95], v34 offset:10016
  v_mfma_f32_16x16x32_bf16 v[188:191], v[60:63], v[112:115], v[188:191]
  ds_read_b128 v[96:99], v34 offset:10272
  v_mfma_f32_16x16x32_bf16 v[192:195], v[60:63], v[116:119], v[192:195]
  ds_read_b128 v[100:103], v34 offset:10528
  v_mfma_f32_16x16x32_bf16 v[196:199], v[60:63], v[120:123], v[196:199]
  ds_read_b128 v[104:107], v34 offset:10784
  v_mfma_f32_16x16x32_bf16 v[200:203], v[60:63], v[124:127], v[200:203]
  ds_read_b128 v[108:111], v34 offset:11040
  v_mfma_f32_16x16x32_bf16 v[204:207], v[60:63], v[128:131], v[204:207]
  s_lshl_b32 s3, s5, 8
  v_mfma_f32_16x16x32_bf16 v[192:195], v[64:67], v[112:115], v[192:195]
  s_sub_u32 s3, 319, s3
  v_mfma_f32_16x16x32_bf16 v[196:199], v[64:67], v[116:119], v[196:199]
  v_sub_u32 v4, s3, v1
  v_mfma_f32_16x16x32_bf16 v[200:203], v[64:67], v[120:123], v[200:203]
  v_lshl_add_u32 v4, v4, 4, s87
  v_mfma_f32_16x16x32_bf16 v[204:207], v[64:67], v[124:127], v[204:207]
  ds_read_b64 v[208:209], v4 offset:3072
  v_mfma_f32_16x16x32_bf16 v[196:199], v[68:71], v[112:115], v[196:199]
  ds_read_b64 v[210:211], v4 offset:2048
  v_mfma_f32_16x16x32_bf16 v[200:203], v[68:71], v[116:119], v[200:203]
  ds_read_b64 v[212:213], v4 offset:1024
  v_mfma_f32_16x16x32_bf16 v[204:207], v[68:71], v[120:123], v[204:207]
  ds_read_b64 v[214:215], v4 offset:0
  v_mfma_f32_16x16x32_bf16 v[200:203], v[72:75], v[112:115], v[200:203]
  s_lshl_b32 s3, s5, 12
  v_mfma_f32_16x16x32_bf16 v[204:207], v[72:75], v[116:119], v[204:207]
  s_add_u32 s3, s3, s86
  v_mfma_f32_16x16x32_bf16 v[204:207], v[76:79], v[112:115], v[204:207]
  v_lshl_add_u32 v232, v1, 4, s3
  s_waitcnt lgkmcnt(5)
  v_mfma_f32_16x16x32_bf16 v[176:179], v[80:83], v[144:147], v[176:179]
  ds_read_b128 v[48:51], v34 offset:64
  v_mfma_f32_16x16x32_bf16 v[180:183], v[80:83], v[148:151], v[180:183]
  ds_read_b128 v[112:115], v35 offset:7424
  v_mfma_f32_16x16x32_bf16 v[184:187], v[80:83], v[152:155], v[184:187]
  ds_read_b128 v[116:119], v35 offset:6400
  v_mfma_f32_16x16x32_bf16 v[188:191], v[80:83], v[156:159], v[188:191]
  ds_read_b128 v[120:123], v35 offset:5376
  v_mfma_f32_16x16x32_bf16 v[192:195], v[80:83], v[160:163], v[192:195]
  ds_read_b128 v[124:127], v35 offset:4352
  v_mfma_f32_16x16x32_bf16 v[196:199], v[80:83], v[164:167], v[196:199]
  ds_read_b128 v[128:131], v35 offset:3328
  v_mfma_f32_16x16x32_bf16 v[200:203], v[80:83], v[168:171], v[200:203]
  ds_read_b128 v[132:135], v35 offset:2304
  v_mfma_f32_16x16x32_bf16 v[204:207], v[80:83], v[172:175], v[204:207]
  ds_read_b128 v[136:139], v35 offset:1280
  v_mfma_f32_16x16x32_bf16 v[180:183], v[84:87], v[144:147], v[180:183]
  ds_read_b128 v[140:143], v35 offset:256
  v_mfma_f32_16x16x32_bf16 v[184:187], v[84:87], v[148:151], v[184:187]
  ds_read_b128 v[52:55], v34 offset:320
  v_mfma_f32_16x16x32_bf16 v[188:191], v[84:87], v[152:155], v[188:191]
  ds_read_b128 v[56:59], v34 offset:576
  v_mfma_f32_16x16x32_bf16 v[192:195], v[84:87], v[156:159], v[192:195]
  ds_read_b128 v[60:63], v34 offset:832
  v_mfma_f32_16x16x32_bf16 v[196:199], v[84:87], v[160:163], v[196:199]
  ds_read_b128 v[64:67], v34 offset:1088
  v_mfma_f32_16x16x32_bf16 v[200:203], v[84:87], v[164:167], v[200:203]
  ds_read_b128 v[68:71], v34 offset:1344
  v_mfma_f32_16x16x32_bf16 v[204:207], v[84:87], v[168:171], v[204:207]
  ds_read_b128 v[72:75], v34 offset:1600
  v_mfma_f32_16x16x32_bf16 v[184:187], v[88:91], v[144:147], v[184:187]
  ds_read_b128 v[76:79], v34 offset:1856
  v_mfma_f32_16x16x32_bf16 v[188:191], v[88:91], v[148:151], v[188:191]
  s_xor_b32 s4, s5, 1
  v_mfma_f32_16x16x32_bf16 v[192:195], v[88:91], v[152:155], v[192:195]
  s_lshl_b32 s3, s4, 12
  v_mfma_f32_16x16x32_bf16 v[196:199], v[88:91], v[156:159], v[196:199]
  s_add_u32 s3, s3, s86
  v_mfma_f32_16x16x32_bf16 v[200:203], v[88:91], v[160:163], v[200:203]
  v_lshl_add_u32 v233, v1, 4, s3
  v_mfma_f32_16x16x32_bf16 v[204:207], v[88:91], v[164:167], v[204:207]
  v_lshlrev_b32 v234, 3, v1
  v_mfma_f32_16x16x32_bf16 v[188:191], v[92:95], v[144:147], v[188:191]
  s_lshl_b32 s3, s5, 11
  v_mfma_f32_16x16x32_bf16 v[192:195], v[92:95], v[148:151], v[192:195]
  s_lshl_b32 s4, s101, 12
  v_mfma_f32_16x16x32_bf16 v[196:199], v[92:95], v[152:155], v[196:199]
  s_add_u32 s3, s3, s4
  v_mfma_f32_16x16x32_bf16 v[200:203], v[92:95], v[156:159], v[200:203]
  s_add_u32 s82, s3, 0x900000
  v_mfma_f32_16x16x32_bf16 v[204:207], v[92:95], v[160:163], v[204:207]
  s_lshl_b32 s28, s9, 10
  v_mfma_f32_16x16x32_bf16 v[192:195], v[96:99], v[144:147], v[192:195]
  s_lshl_b32 s4, s5, 9
  v_mfma_f32_16x16x32_bf16 v[196:199], v[96:99], v[148:151], v[196:199]
  s_add_u32 s28, s28, s4
  v_mfma_f32_16x16x32_bf16 v[200:203], v[96:99], v[152:155], v[200:203]
  s_and_b32 s4, s101, 63
  v_mfma_f32_16x16x32_bf16 v[204:207], v[96:99], v[156:159], v[204:207]
  s_lshl_b32 s4, s4, 3
  v_mfma_f32_16x16x32_bf16 v[196:199], v[100:103], v[144:147], v[196:199]
  s_add_u32 s28, s28, s4
  v_mfma_f32_16x16x32_bf16 v[200:203], v[100:103], v[148:151], v[200:203]
  s_add_u32 s28, s28, 0xd08000
  v_mfma_f32_16x16x32_bf16 v[204:207], v[100:103], v[152:155], v[204:207]
  s_waitcnt lgkmcnt(15)
  v_mfma_f32_16x16x32_bf16 v[200:203], v[104:107], v[144:147], v[200:203]
  v_and_b32 v216, s15, v209
  v_mfma_f32_16x16x32_bf16 v[204:207], v[104:107], v[148:151], v[204:207]
  v_lshlrev_b32 v217, 16, v209
  v_mfma_f32_16x16x32_bf16 v[204:207], v[108:111], v[144:147], v[204:207]
  v_and_b32 v218, s15, v208
  s_waitcnt lgkmcnt(1)
  v_mfma_f32_16x16x32_bf16 v[176:179], v[48:51], v[112:115], v[176:179]
  ds_read_b128 v[80:83], v34 offset:9312
  v_mfma_f32_16x16x32_bf16 v[180:183], v[48:51], v[116:119], v[180:183]
  ds_read_b128 v[144:147], v35 offset:7552
  v_mfma_f32_16x16x32_bf16 v[184:187], v[48:51], v[120:123], v[184:187]
  ds_read_b128 v[148:151], v35 offset:6528
  v_mfma_f32_16x16x32_bf16 v[188:191], v[48:51], v[124:127], v[188:191]
  ds_read_b128 v[152:155], v35 offset:5504
  v_mfma_f32_16x16x32_bf16 v[192:195], v[48:51], v[128:131], v[192:195]
  ds_read_b128 v[156:159], v35 offset:4480
  v_mfma_f32_16x16x32_bf16 v[196:199], v[48:51], v[132:135], v[196:199]
  ds_read_b128 v[160:163], v35 offset:3456
  v_mfma_f32_16x16x32_bf16 v[200:203], v[48:51], v[136:139], v[200:203]
  ds_read_b128 v[164:167], v35 offset:2432
  v_mfma_f32_16x16x32_bf16 v[204:207], v[48:51], v[140:143], v[204:207]
  ds_read_b128 v[168:171], v35 offset:1408
  v_mfma_f32_16x16x32_bf16 v[180:183], v[52:55], v[112:115], v[180:183]
  ds_read_b128 v[172:175], v35 offset:384
  v_mfma_f32_16x16x32_bf16 v[184:187], v[52:55], v[116:119], v[184:187]
  ds_read_b128 v[84:87], v34 offset:9568
  v_mfma_f32_16x16x32_bf16 v[188:191], v[52:55], v[120:123], v[188:191]
  ds_read_b128 v[88:91], v34 offset:9824
  v_mfma_f32_16x16x32_bf16 v[192:195], v[52:55], v[124:127], v[192:195]
  ds_read_b128 v[92:95], v34 offset:10080
  v_mfma_f32_16x16x32_bf16 v[196:199], v[52:55], v[128:131], v[196:199]
  ds_read_b128 v[96:99], v34 offset:10336
  v_mfma_f32_16x16x32_bf16 v[200:203], v[52:55], v[132:135], v[200:203]
  ds_read_b128 v[100:103], v34 offset:10592
  v_mfma_f32_16x16x32_bf16 v[204:207], v[52:55], v[136:139], v[204:207]
  ds_read_b128 v[104:107], v34 offset:10848
  v_mfma_f32_16x16x32_bf16 v[184:187], v[56:59], v[112:115], v[184:187]
  ds_read_b128 v[108:111], v34 offset:11104
  v_mfma_f32_16x16x32_bf16 v[188:191], v[56:59], v[116:119], v[188:191]
  v_lshlrev_b32 v219, 16, v208
  v_mfma_f32_16x16x32_bf16 v[192:195], v[56:59], v[120:123], v[192:195]
  v_mul_f32 v216, v216, v36
  v_mfma_f32_16x16x32_bf16 v[196:199], v[56:59], v[124:127], v[196:199]
  v_mul_f32 v217, v217, v36
  v_mfma_f32_16x16x32_bf16 v[200:203], v[56:59], v[128:131], v[200:203]
  v_mul_f32 v218, v218, v36
  v_mfma_f32_16x16x32_bf16 v[204:207], v[56:59], v[132:135], v[204:207]
  v_mul_f32 v219, v219, v36
  v_mfma_f32_16x16x32_bf16 v[188:191], v[60:63], v[112:115], v[188:191]
  v_cvt_pk_bf16_f32 v6, v216, v217
  v_mfma_f32_16x16x32_bf16 v[192:195], v[60:63], v[116:119], v[192:195]
  v_lshlrev_b32 v216, 16, v6
  v_mfma_f32_16x16x32_bf16 v[196:199], v[60:63], v[120:123], v[196:199]
  v_and_b32 v217, s15, v6
  v_mfma_f32_16x16x32_bf16 v[200:203], v[60:63], v[124:127], v[200:203]
  v_cvt_pk_bf16_f32 v6, v218, v219
  v_mfma_f32_16x16x32_bf16 v[204:207], v[60:63], v[128:131], v[204:207]
  v_lshlrev_b32 v218, 16, v6
  v_mfma_f32_16x16x32_bf16 v[192:195], v[64:67], v[112:115], v[192:195]
  v_and_b32 v219, s15, v6
  v_mfma_f32_16x16x32_bf16 v[196:199], v[64:67], v[116:119], v[196:199]
  v_and_b32 v220, s15, v211
  v_mfma_f32_16x16x32_bf16 v[200:203], v[64:67], v[120:123], v[200:203]
  v_lshlrev_b32 v221, 16, v211
  v_mfma_f32_16x16x32_bf16 v[204:207], v[64:67], v[124:127], v[204:207]
  v_and_b32 v222, s15, v210
  v_mfma_f32_16x16x32_bf16 v[196:199], v[68:71], v[112:115], v[196:199]
  v_lshlrev_b32 v223, 16, v210
  v_mfma_f32_16x16x32_bf16 v[200:203], v[68:71], v[116:119], v[200:203]
  v_mul_f32 v220, v220, v36
  v_mfma_f32_16x16x32_bf16 v[204:207], v[68:71], v[120:123], v[204:207]
  v_mul_f32 v221, v221, v36
  v_mfma_f32_16x16x32_bf16 v[200:203], v[72:75], v[112:115], v[200:203]
  v_mul_f32 v222, v222, v36
  v_mfma_f32_16x16x32_bf16 v[204:207], v[72:75], v[116:119], v[204:207]
  v_mul_f32 v223, v223, v36
  v_mfma_f32_16x16x32_bf16 v[204:207], v[76:79], v[112:115], v[204:207]
  v_cvt_pk_bf16_f32 v6, v220, v221
  s_waitcnt lgkmcnt(1)
  s_mov_b64 exec, 1
  ds_add_u32 v42, v11 offset:56
  s_mov_b64 exec, -1
  v_mfma_f32_16x16x32_bf16 v[176:179], v[80:83], v[144:147], v[176:179]
  v_lshlrev_b32 v220, 16, v6
  v_mfma_f32_16x16x32_bf16 v[180:183], v[80:83], v[148:151], v[180:183]
  v_and_b32 v221, s15, v6
  v_mfma_f32_16x16x32_bf16 v[184:187], v[80:83], v[152:155], v[184:187]
  v_cvt_pk_bf16_f32 v6, v222, v223
  v_mfma_f32_16x16x32_bf16 v[188:191], v[80:83], v[156:159], v[188:191]
  v_lshlrev_b32 v222, 16, v6
  v_mfma_f32_16x16x32_bf16 v[192:195], v[80:83], v[160:163], v[192:195]
  v_and_b32 v223, s15, v6
  v_mfma_f32_16x16x32_bf16 v[196:199], v[80:83], v[164:167], v[196:199]
  v_and_b32 v224, s15, v213
  v_mfma_f32_16x16x32_bf16 v[200:203], v[80:83], v[168:171], v[200:203]
  v_lshlrev_b32 v225, 16, v213
  v_mfma_f32_16x16x32_bf16 v[204:207], v[80:83], v[172:175], v[204:207]
  v_and_b32 v226, s15, v212
  v_mfma_f32_16x16x32_bf16 v[180:183], v[84:87], v[144:147], v[180:183]
  v_lshlrev_b32 v227, 16, v212
  v_mfma_f32_16x16x32_bf16 v[184:187], v[84:87], v[148:151], v[184:187]
  v_mul_f32 v224, v224, v36
  v_mfma_f32_16x16x32_bf16 v[188:191], v[84:87], v[152:155], v[188:191]
  v_mul_f32 v225, v225, v36
  v_mfma_f32_16x16x32_bf16 v[192:195], v[84:87], v[156:159], v[192:195]
  v_mul_f32 v226, v226, v36
  v_mfma_f32_16x16x32_bf16 v[196:199], v[84:87], v[160:163], v[196:199]
  v_mul_f32 v227, v227, v36
  v_mfma_f32_16x16x32_bf16 v[200:203], v[84:87], v[164:167], v[200:203]
  v_cvt_pk_bf16_f32 v6, v224, v225
  v_mfma_f32_16x16x32_bf16 v[204:207], v[84:87], v[168:171], v[204:207]
  v_lshlrev_b32 v224, 16, v6
  v_mfma_f32_16x16x32_bf16 v[184:187], v[88:91], v[144:147], v[184:187]
  v_and_b32 v225, s15, v6
  v_mfma_f32_16x16x32_bf16 v[188:191], v[88:91], v[148:151], v[188:191]
  v_cvt_pk_bf16_f32 v6, v226, v227
  v_mfma_f32_16x16x32_bf16 v[192:195], v[88:91], v[152:155], v[192:195]
  v_lshlrev_b32 v226, 16, v6
  v_mfma_f32_16x16x32_bf16 v[196:199], v[88:91], v[156:159], v[196:199]
  v_and_b32 v227, s15, v6
  v_mfma_f32_16x16x32_bf16 v[200:203], v[88:91], v[160:163], v[200:203]
  v_and_b32 v228, s15, v215
  v_mfma_f32_16x16x32_bf16 v[204:207], v[88:91], v[164:167], v[204:207]
  v_lshlrev_b32 v229, 16, v215
  v_mfma_f32_16x16x32_bf16 v[188:191], v[92:95], v[144:147], v[188:191]
  v_and_b32 v230, s15, v214
  v_mfma_f32_16x16x32_bf16 v[192:195], v[92:95], v[148:151], v[192:195]
  v_lshlrev_b32 v231, 16, v214
  v_mfma_f32_16x16x32_bf16 v[196:199], v[92:95], v[152:155], v[196:199]
  v_mul_f32 v228, v228, v36
  v_mfma_f32_16x16x32_bf16 v[200:203], v[92:95], v[156:159], v[200:203]
  v_mul_f32 v229, v229, v36
  v_mfma_f32_16x16x32_bf16 v[204:207], v[92:95], v[160:163], v[204:207]
  v_mul_f32 v230, v230, v36
  v_mfma_f32_16x16x32_bf16 v[192:195], v[96:99], v[144:147], v[192:195]
  v_mul_f32 v231, v231, v36
  v_mfma_f32_16x16x32_bf16 v[196:199], v[96:99], v[148:151], v[196:199]
  v_cvt_pk_bf16_f32 v6, v228, v229
  v_mfma_f32_16x16x32_bf16 v[200:203], v[96:99], v[152:155], v[200:203]
  v_lshlrev_b32 v228, 16, v6
  v_mfma_f32_16x16x32_bf16 v[204:207], v[96:99], v[156:159], v[204:207]
  v_and_b32 v229, s15, v6
  v_mfma_f32_16x16x32_bf16 v[196:199], v[100:103], v[144:147], v[196:199]
  v_cvt_pk_bf16_f32 v6, v230, v231
  v_mfma_f32_16x16x32_bf16 v[200:203], v[100:103], v[148:151], v[200:203]
  v_lshlrev_b32 v230, 16, v6
  v_mfma_f32_16x16x32_bf16 v[204:207], v[100:103], v[152:155], v[204:207]
  v_and_b32 v231, s15, v6
  v_mfma_f32_16x16x32_bf16 v[200:203], v[104:107], v[144:147], v[200:203]
  v_mfma_f32_16x16x32_bf16 v[204:207], v[104:107], v[148:151], v[204:207]
  v_mfma_f32_16x16x32_bf16 v[204:207], v[108:111], v[144:147], v[204:207]
  s_nop 4
  s_cmp_eq_u32 s5, 0
  s_cbranch_scc1 L_noswap
  v_swap_b32 v176, v192
  v_swap_b32 v177, v193
  v_swap_b32 v178, v194
  v_swap_b32 v179, v195
  v_swap_b32 v180, v196
  v_swap_b32 v181, v197
  v_swap_b32 v182, v198
  v_swap_b32 v183, v199
  v_swap_b32 v184, v200
  v_swap_b32 v185, v201
  v_swap_b32 v186, v202
  v_swap_b32 v187, v203
  v_swap_b32 v188, v204
  v_swap_b32 v189, v205
  v_swap_b32 v190, v206
  v_swap_b32 v191, v207
L_noswap:
  s_setprio 1
Lh10:
  ds_read_b32 v8, v42 offset:56
  s_waitcnt lgkmcnt(0)
  v_cmp_gt_u32 vcc, 4, v8
  s_cbranch_vccz Lh10_x
  s_sub_u32 s30, s30, 1
  s_cmp_gt_i32 s30, 0
  s_cbranch_scc1 Lh10
Lh10_x:
  ds_write_b128 v232, v[192:195] offset:0
  ds_write_b128 v232, v[196:199] offset:1024
  ds_write_b128 v232, v[200:203] offset:2048
  ds_write_b128 v232, v[204:207] offset:3072
  s_mov_b64 exec, 1
  ds_add_u32 v42, v11 offset:64
  s_mov_b64 exec, -1
Lh11:
  ds_read_b32 v8, v42 offset:64
  s_waitcnt lgkmcnt(0)
  v_cmp_gt_u32 vcc, 2, v8
  s_cbranch_vccz Lh11_x
  s_sub_u32 s30, s30, 1
  s_cmp_gt_i32 s30, 0
  s_cbranch_scc1 Lh11
Lh11_x:
  ds_read_b128 v[112:115], v233 offset:0
  ds_read_b128 v[116:119], v233 offset:1024
  ds_read_b128 v[120:123], v233 offset:2048
  ds_read_b128 v[124:127], v233 offset:3072
  s_waitcnt lgkmcnt(3)
  v_add_f32 v176, v176, v112
  v_add_f32 v177, v177, v113
  v_cvt_pk_bf16_f32 v6, v176, v177
  v_lshlrev_b32 v176, 16, v6
  v_and_b32 v177, s15, v6
  v_add_f32 v176, v176, v216
  v_add_f32 v177, v177, v217
  v_cvt_pk_bf16_f32 v144, v176, v177
  v_add_f32 v178, v178, v114
  v_add_f32 v179, v179, v115
  v_cvt_pk_bf16_f32 v6, v178, v179
  v_lshlrev_b32 v178, 16, v6
  v_and_b32 v179, s15, v6
  v_add_f32 v178, v178, v218
  v_add_f32 v179, v179, v219
  v_cvt_pk_bf16_f32 v145, v178, v179
  buffer_store_dwordx2 v[144:145], v234, s[52:55], s82 offen offset:0 sc1
  s_waitcnt lgkmcnt(2)
  v_add_f32 v180, v180, v116
  v_add_f32 v181, v181, v117
  v_cvt_pk_bf16_f32 v6, v180, v181
  v_lshlrev_b32 v180, 16, v6
  v_and_b32 v181, s15, v6
  v_add_f32 v180, v180, v220
  v_add_f32 v181, v181, v221
  v_cvt_pk_bf16_f32 v146, v180, v181
  v_add_f32 v182, v182, v118
  v_add_f32 v183, v183, v119
  v_cvt_pk_bf16_f32 v6, v182, v183
  v_lshlrev_b32 v182, 16, v6
  v_and_b32 v183, s15, v6
  v_add_f32 v182, v182, v222
  v_add_f32 v183, v183, v223
  v_cvt_pk_bf16_f32 v147, v182, v183
  buffer_store_dwordx2 v[146:147], v234, s[52:55], s82 offen offset:512 sc1
  s_waitcnt lgkmcnt(1)
  v_add_f32 v184, v184, v120
  v_add_f32 v185, v185, v121
  v_cvt_pk_bf16_f32 v6, v184, v185
  v_lshlrev_b32 v184, 16, v6
  v_and_b32 v185, s15, v6
  v_add_f32 v184, v184, v224
  v_add_f32 v185, v185, v225
  v_cvt_pk_bf16_f32 v148, v184, v185
  v_add_f32 v186, v186, v122
  v_add_f32 v187, v187, v123
  v_cvt_pk_bf16_f32 v6, v186, v187
  v_lshlrev_b32 v186, 16, v6
  v_and_b32 v187, s15, v6
  v_add_f32 v186, v186, v226
  v_add_f32 v187, v187, v227
  v_cvt_pk_bf16_f32 v149, v186, v187
  buffer_store_dwordx2 v[148:149], v234, s[52:55], s82 offen offset:1024 sc1
  s_waitcnt lgkmcnt(0)
  v_add_f32 v188, v188, v124
  v_add_f32 v189, v189, v125
  v_cvt_pk_bf16_f32 v6, v188, v189
  v_lshlrev_b32 v188, 16, v6
  v_and_b32 v189, s15, v6
  v_add_f32 v188, v188, v228
  v_add_f32 v189, v189, v229
  v_cvt_pk_bf16_f32 v150, v188, v189
  v_add_f32 v190, v190, v126
  v_add_f32 v191, v191, v127
  v_cvt_pk_bf16_f32 v6, v190, v191
  v_lshlrev_b32 v190, 16, v6
  v_and_b32 v191, s15, v6
  v_add_f32 v190, v190, v230
  v_add_f32 v191, v191, v231
  v_cvt_pk_bf16_f32 v151, v190, v191
  buffer_store_dwordx2 v[150:151], v234, s[52:55], s82 offen offset:1536 sc1
  s_mov_b64 exec, 1
  ds_add_u32 v10, v11 offset:132
  s_mov_b64 exec, -1
  v_and_b32 v2, 15, v1
  s_lshl_b32 s3, s13, 6
  v_add_u32 v2, s3, v2
  v_and_b32 v67, 15, v1
  v_lshlrev_b32 v67, 3, v67
  v_add_u32 v67, 124160, v67
  v_lshrrev_b32 v3, 4, v1
  s_lshl_b32 s3, s14, 7
  s_lshl_b32 s4, s8, 5
  s_add_u32 s3, s3, s4
  v_lshl_add_u32 v4, v3, 3, s3
  v_lshl_add_u32 v64, v2, 10, v4
  v_and_b32 v65, 7, v1
  v_lshrrev_b32 v2, 3, v1
  v_lshlrev_b32 v2, 12, v2
  v_lshl_add_u32 v66, v65, 4, v2
  v_lshlrev_b32 v65, 3, v1
  s_lshl_b32 s97, s14, 10
  s_lshr_b32 s4, s13, 4
  s_lshl_b32 s4, s4, 9
  s_add_u32 s97, s97, s4
  s_add_u32 s97, s97, 0xd08000
  s_lshl_b32 s3, s14, 18
  s_lshl_b32 s4, s8, 16
  s_add_u32 s3, s3, s4
  s_lshl_b32 s4, s13, 7
  s_add_u32 s3, s3, s4
  s_add_u32 s92, s3, 0x900000
  s_add_u32 s93, s92, 0x8000
  s_lshl_b32 s3, s5, 11
  s_lshr_b32 s4, s8, 1
  s_mul_i32 s4, s4, 40192
  s_add_u32 s3, s3, s4
  s_add_u32 s3, s3, 119552
  v_lshl_add_u32 v68, v1, 4, s3
  v_lshrrev_b32 v2, 2, v1
  v_lshlrev_b32 v2, 7, v2
  v_and_b32 v3, 3, v1
  v_lshl_add_u32 v2, v3, 3, v2
  v_add_u32 v2, s3, v2
  s_lshl_b32 s3, s8, 12
  v_lshl_add_u32 v70, v1, 4, s3
  v_add_u32 v69, 126976, v70
  v_lshlrev_b32 v88, 16, v240
  v_and_b32 v89, s15, v240
  v_lshlrev_b32 v90, 16, v241
  v_and_b32 v91, s15, v241
  v_lshlrev_b32 v92, 16, v242
  v_and_b32 v93, s15, v242
  v_lshlrev_b32 v94, 16, v243
  v_and_b32 v95, s15, v243
  v_lshlrev_b32 v96, 16, v244
  v_and_b32 v97, s15, v244
  v_lshlrev_b32 v98, 16, v245
  v_and_b32 v99, s15, v245
  v_lshlrev_b32 v100, 16, v246
  v_and_b32 v101, s15, v246
  v_lshlrev_b32 v102, 16, v247
  v_and_b32 v103, s15, v247
  v_lshlrev_b32 v104, 16, v248
  v_and_b32 v105, s15, v248
  v_lshlrev_b32 v106, 16, v249
  v_and_b32 v107, s15, v249
  s_waitcnt vmcnt(0)
  s_mov_b64 exec, 1
  buffer_store_dwordx2 v[16:17], v9, s[52:55], s28 offen sc1
  s_mov_b64 exec, -1
  s_setprio 1
  s_cmp_lg_u32 s8, 0
  s_cbranch_scc1 L_noyp
Lh12:
  ds_read_b32 v8, v10 offset:140
  s_waitcnt lgkmcnt(0)
  v_cmp_gt_u32 vcc, 2, v8
  s_cbranch_vccz Lh12_x
  s_sleep 1
  s_sub_u32 s30, s30, 1
  s_cmp_gt_i32 s30, 0
  s_cbranch_scc1 Lh12
Lh12_x:
Lh13:
  ds_read_b32 v8, v10 offset:136
  s_waitcnt lgkmcnt(0)
  v_cmp_gt_u32 vcc, 1, v8
  s_cbranch_vccz Lh13_x
  s_sleep 1
  s_sub_u32 s30, s30, 1
  s_cmp_gt_i32 s30, 0
  s_cbranch_scc1 Lh13
Lh13_x:
  s_lshl_b32 s3, s13, 9
  s_add_u32 s3, s3, 0xb00000
  buffer_load_dwordx2 v[56:57], v65, s[52:55], s3 offen sc1
  s_mov_b32 s4, 0
Lh14:
  buffer_load_dwordx2 v[40:41], v65, s[52:55], s97 offen sc1
  s_add_u32 s4, s4, 1
  s_waitcnt vmcnt(0)
  v_cmp_ne_u64 vcc, v[40:41], v[16:17]
  s_cmp_ge_u32 s4, 30000
  s_cbranch_scc1 Lh14_x
  s_cbranch_vccz Lh14_x
  s_sleep 2
  s_branch Lh14
Lh14_x:
  v_add_u32 v65, 124160, v65
  ds_write_b64 v65, v[56:57]
  s_mov_b64 exec, 1
  ds_add_u32 v10, v11 offset:128
  s_mov_b64 exec, -1
L_noyp:
Lh15:
  ds_read_b32 v8, v10 offset:128
  s_waitcnt lgkmcnt(0)
  v_cmp_gt_u32 vcc, 1, v8
  s_cbranch_vccz Lh15_x
  s_sleep 1
  s_sub_u32 s30, s30, 1
  s_cmp_gt_i32 s30, 0
  s_cbranch_scc1 Lh15
Lh15_x:
  buffer_load_dwordx4 v[48:51], v66, s[52:55], s92 offen sc1
  buffer_load_dwordx4 v[52:55], v66, s[52:55], s93 offen sc1
  ds_read_b64 v[56:57], v67 offset:0
  ds_read_b64 v[58:59], v67 offset:128
  ds_read_b64 v[60:61], v67 offset:256
  ds_read_b64 v[62:63], v67 offset:384
  s_waitcnt lgkmcnt(0)
  v_sub_f32 v72, v88, v56
  v_sub_f32 v73, v89, v56
  v_cvt_pk_bf16_f32 v6, v72, v73
  v_lshlrev_b32 v72, 16, v6
  v_and_b32 v73, s15, v6
  v_mul_f32 v72, v72, v57
  v_mul_f32 v73, v73, v57
  v_cvt_pk_bf16_f32 v6, v72, v73
  v_lshlrev_b32 v72, 16, v6
  v_and_b32 v73, s15, v6
  v_sub_f32 v74, v90, v56
  v_sub_f32 v75, v91, v56
  v_cvt_pk_bf16_f32 v6, v74, v75
  v_lshlrev_b32 v74, 16, v6
  v_and_b32 v75, s15, v6
  v_mul_f32 v74, v74, v57
  v_mul_f32 v75, v75, v57
  v_cvt_pk_bf16_f32 v6, v74, v75
  v_lshlrev_b32 v74, 16, v6
  v_and_b32 v75, s15, v6
  v_sub_f32 v76, v92, v58
  v_sub_f32 v77, v93, v58
  v_cvt_pk_bf16_f32 v6, v76, v77
  v_lshlrev_b32 v76, 16, v6
  v_and_b32 v77, s15, v6
  v_mul_f32 v76, v76, v59
  v_mul_f32 v77, v77, v59
  v_cvt_pk_bf16_f32 v6, v76, v77
  v_lshlrev_b32 v76, 16, v6
  v_and_b32 v77, s15, v6
  v_sub_f32 v78, v94, v58
  v_sub_f32 v79, v95, v58
  v_cvt_pk_bf16_f32 v6, v78, v79
  v_lshlrev_b32 v78, 16, v6
  v_and_b32 v79, s15, v6
  v_mul_f32 v78, v78, v59
  v_mul_f32 v79, v79, v59
  v_cvt_pk_bf16_f32 v6, v78, v79
  v_lshlrev_b32 v78, 16, v6
  v_and_b32 v79, s15, v6
  v_sub_f32 v80, v96, v60
  v_sub_f32 v81, v97, v60
  v_cvt_pk_bf16_f32 v6, v80, v81
  v_lshlrev_b32 v80, 16, v6
  v_and_b32 v81, s15, v6
  v_mul_f32 v80, v80, v61
  v_mul_f32 v81, v81, v61
  v_cvt_pk_bf16_f32 v6, v80, v81
  v_lshlrev_b32 v80, 16, v6
  v_and_b32 v81, s15, v6
  v_sub_f32 v82, v98, v60
  v_sub_f32 v83, v99, v60
  v_cvt_pk_bf16_f32 v6, v82, v83
  v_lshlrev_b32 v82, 16, v6
  v_and_b32 v83, s15, v6
  v_mul_f32 v82, v82, v61
  v_mul_f32 v83, v83, v61
  v_cvt_pk_bf16_f32 v6, v82, v83
  v_lshlrev_b32 v82, 16, v6
  v_and_b32 v83, s15, v6
  v_sub_f32 v84, v100, v62
  v_sub_f32 v85, v101, v62
  v_cvt_pk_bf16_f32 v6, v84, v85
  v_lshlrev_b32 v84, 16, v6
  v_and_b32 v85, s15, v6
  v_mul_f32 v84, v84, v63
  v_mul_f32 v85, v85, v63
  v_cvt_pk_bf16_f32 v6, v84, v85
  v_lshlrev_b32 v84, 16, v6
  v_and_b32 v85, s15, v6
  v_sub_f32 v86, v102, v62
  v_sub_f32 v87, v103, v62
  v_cvt_pk_bf16_f32 v6, v86, v87
  v_lshlrev_b32 v86, 16, v6
  v_and_b32 v87, s15, v6
  v_mul_f32 v86, v86, v63
  v_mul_f32 v87, v87, v63
  v_cvt_pk_bf16_f32 v6, v86, v87
  v_lshlrev_b32 v86, 16, v6
  v_and_b32 v87, s15, v6
Lh16:
  ds_read_b32 v8, v10 offset:132
  s_waitcnt lgkmcnt(0)
  v_cmp_gt_u32 vcc, 4, v8
  s_cbranch_vccz Lh16_x
  s_sleep 1
  s_sub_u32 s30, s30, 1
  s_cmp_gt_i32 s30, 0
  s_cbranch_scc1 Lh16
Lh16_x:
  s_waitcnt vmcnt(0)
  ds_write_b128 v68, v[48:51]
  ds_write_b128 v68, v[52:55] offset:1024
  ds_read_b64_tr_b16 v[108:109], v2 offset:0
  ds_read_b64_tr_b16 v[110:111], v2 offset:32
  ds_read_b64_tr_b16 v[112:113], v2 offset:64
  ds_read_b64_tr_b16 v[114:115], v2 offset:96
  s_mov_b32 s4, 0xbfb8aa3b
  s_waitcnt lgkmcnt(0)
  v_lshlrev_b32 v116, 16, v108
  v_and_b32 v117, s15, v108
  v_mul_f32 v72, v72, v116
  v_mul_f32 v73, v73, v117
  v_cvt_pk_bf16_f32 v6, v72, v73
  v_lshlrev_b32 v72, 16, v6
  v_and_b32 v73, s15, v6
  v_lshlrev_b32 v116, 16, v109
  v_and_b32 v117, s15, v109
  v_mul_f32 v74, v74, v116
  v_mul_f32 v75, v75, v117
  v_cvt_pk_bf16_f32 v6, v74, v75
  v_lshlrev_b32 v74, 16, v6
  v_and_b32 v75, s15, v6
  v_lshlrev_b32 v116, 16, v110
  v_and_b32 v117, s15, v110
  v_mul_f32 v76, v76, v116
  v_mul_f32 v77, v77, v117
  v_cvt_pk_bf16_f32 v6, v76, v77
  v_lshlrev_b32 v76, 16, v6
  v_and_b32 v77, s15, v6
  v_lshlrev_b32 v116, 16, v111
  v_and_b32 v117, s15, v111
  v_mul_f32 v78, v78, v116
  v_mul_f32 v79, v79, v117
  v_cvt_pk_bf16_f32 v6, v78, v79
  v_lshlrev_b32 v78, 16, v6
  v_and_b32 v79, s15, v6
  v_lshlrev_b32 v116, 16, v112
  v_and_b32 v117, s15, v112
  v_mul_f32 v80, v80, v116
  v_mul_f32 v81, v81, v117
  v_cvt_pk_bf16_f32 v6, v80, v81
  v_lshlrev_b32 v80, 16, v6
  v_and_b32 v81, s15, v6
  v_lshlrev_b32 v116, 16, v113
  v_and_b32 v117, s15, v113
  v_mul_f32 v82, v82, v116
  v_mul_f32 v83, v83, v117
  v_cvt_pk_bf16_f32 v6, v82, v83
  v_lshlrev_b32 v82, 16, v6
  v_and_b32 v83, s15, v6
  v_lshlrev_b32 v116, 16, v114
  v_and_b32 v117, s15, v114
  v_mul_f32 v84, v84, v116
  v_mul_f32 v85, v85, v117
  v_cvt_pk_bf16_f32 v6, v84, v85
  v_lshlrev_b32 v84, 16, v6
  v_and_b32 v85, s15, v6
  v_lshlrev_b32 v116, 16, v115
  v_and_b32 v117, s15, v115
  v_mul_f32 v86, v86, v116
  v_mul_f32 v87, v87, v117
  v_cvt_pk_bf16_f32 v6, v86, v87
  v_lshlrev_b32 v86, 16, v6
  v_and_b32 v87, s15, v6
  s_setprio 3
Lh17:
  ds_read_b32 v8, v10 offset:112
  s_waitcnt lgkmcnt(0)
  v_cmp_gt_u32 vcc, 4, v8
  s_cbranch_vccz Lh17_x
  s_sub_u32 s30, s30, 1
  s_cmp_gt_i32 s30, 0
  s_cbranch_scc1 Lh17
Lh17_x:
  ds_read_b128 v[176:179], v69 offset:0
  ds_read_b128 v[180:183], v69 offset:1024
  ds_read_b128 v[184:187], v69 offset:2048
  ds_read_b128 v[188:191], v69 offset:3072
  s_mov_b32 s3, 0
  s_waitcnt lgkmcnt(0)
  v_add_f32 v176, v176, v180
  v_add_f32 v178, v178, v182
  v_add_f32 v177, v177, v181
  v_add_f32 v179, v179, v183
  v_add_f32 v152, v184, v188
  v_add_f32 v154, v186, v190
  v_add_f32 v153, v185, v189
  v_add_f32 v155, v187, v191
  v_add_f32 v176, v176, v152
  v_add_f32 v178, v178, v154
  v_add_f32 v177, v177, v153
  v_add_f32 v179, v179, v155
  v_cvt_pk_bf16_f32 v6, v176, v177
  v_cvt_pk_bf16_f32 v3, v178, v179
  v_lshlrev_b32 v176, 16, v6
  v_lshlrev_b32 v178, 16, v3
  v_and_b32 v177, s15, v6
  v_and_b32 v179, s15, v3
  v_add_f32 v176, v176, v104
  v_add_f32 v178, v178, v106
  v_add_f32 v177, v177, v105
  v_add_f32 v179, v179, v107
  v_cvt_pk_bf16_f32 v6, v176, v177
  v_cvt_pk_bf16_f32 v3, v178, v179
  v_lshlrev_b32 v176, 16, v6
  v_lshlrev_b32 v178, 16, v3
  v_and_b32 v177, s15, v6
  v_and_b32 v179, s15, v3
  v_mul_f32 v152, s4, v176
  v_mul_f32 v154, s4, v178
  v_mul_f32 v153, s4, v177
  v_mul_f32 v155, s4, v179
  v_exp_f32 v152, v152
  v_exp_f32 v154, v154
  v_exp_f32 v153, v153
  v_exp_f32 v155, v155
  v_add_f32 v152, 1.0, v152
  v_add_f32 v154, 1.0, v154
  v_add_f32 v153, 1.0, v153
  v_add_f32 v155, 1.0, v155
  v_rcp_f32 v152, v152
  v_rcp_f32 v154, v154
  v_rcp_f32 v153, v153
  v_rcp_f32 v155, v155
  v_mul_f32 v152, v152, v176
  v_mul_f32 v154, v154, v178
  v_mul_f32 v153, v153, v177
  v_mul_f32 v155, v155, v179
  v_cvt_pk_bf16_f32 v6, v152, v153
  v_cvt_pk_bf16_f32 v3, v154, v155
  v_lshlrev_b32 v152, 16, v6
  v_lshlrev_b32 v154, 16, v3
  v_and_b32 v153, s15, v6
  v_and_b32 v155, s15, v3
  v_mul_f32 v152, v152, v72
  v_mul_f32 v154, v154, v74
  v_mul_f32 v153, v153, v73
  v_mul_f32 v155, v155, v75
  v_cvt_pk_bf16_f32 v6, v152, v153
  v_cvt_pk_bf16_f32 v3, v154, v155
  v_lshlrev_b32 v152, 16, v6
  v_lshlrev_b32 v154, 16, v3
  v_and_b32 v153, s15, v6
  v_and_b32 v155, s15, v3
  v_add_f32 v152, v152, v88
  v_add_f32 v154, v154, v90
  v_add_f32 v153, v153, v89
  v_add_f32 v155, v155, v91
  v_cvt_pk_bf16_f32 v160, v152, v153
  v_cvt_pk_bf16_f32 v161, v154, v155
  buffer_store_dwordx2 v[160:161], v64, s[76:79], s3 offen
Lh18:
  ds_read_b32 v8, v10 offset:120
  s_waitcnt lgkmcnt(0)
  v_cmp_gt_u32 vcc, 4, v8
  s_cbranch_vccz Lh18_x
  s_sub_u32 s30, s30, 1
  s_cmp_gt_i32 s30, 0
  s_cbranch_scc1 Lh18
Lh18_x:
  ds_read_b128 v[176:179], v69 offset:16384
  ds_read_b128 v[180:183], v69 offset:17408
  ds_read_b128 v[184:187], v69 offset:18432
  ds_read_b128 v[188:191], v69 offset:19456
  s_mov_b32 s3, 32768
  s_waitcnt lgkmcnt(0)
  v_add_f32 v176, v176, v180
  v_add_f32 v178, v178, v182
  v_add_f32 v177, v177, v181
  v_add_f32 v179, v179, v183
  v_add_f32 v152, v184, v188
  v_add_f32 v154, v186, v190
  v_add_f32 v153, v185, v189
  v_add_f32 v155, v187, v191
  v_add_f32 v176, v176, v152
  v_add_f32 v178, v178, v154
  v_add_f32 v177, v177, v153
  v_add_f32 v179, v179, v155
  v_cvt_pk_bf16_f32 v6, v176, v177
  v_cvt_pk_bf16_f32 v3, v178, v179
  v_lshlrev_b32 v176, 16, v6
  v_lshlrev_b32 v178, 16, v3
  v_and_b32 v177, s15, v6
  v_and_b32 v179, s15, v3
  v_add_f32 v176, v176, v104
  v_add_f32 v178, v178, v106
  v_add_f32 v177, v177, v105
  v_add_f32 v179, v179, v107
  v_cvt_pk_bf16_f32 v6, v176, v177
  v_cvt_pk_bf16_f32 v3, v178, v179
  v_lshlrev_b32 v176, 16, v6
  v_lshlrev_b32 v178, 16, v3
  v_and_b32 v177, s15, v6
  v_and_b32 v179, s15, v3
  v_mul_f32 v152, s4, v176
  v_mul_f32 v154, s4, v178
  v_mul_f32 v153, s4, v177
  v_mul_f32 v155, s4, v179
  v_exp_f32 v152, v152
  v_exp_f32 v154, v154
  v_exp_f32 v153, v153
  v_exp_f32 v155, v155
  v_add_f32 v152, 1.0, v152
  v_add_f32 v154, 1.0, v154
  v_add_f32 v153, 1.0, v153
  v_add_f32 v155, 1.0, v155
  v_rcp_f32 v152, v152
  v_rcp_f32 v154, v154
  v_rcp_f32 v153, v153
  v_rcp_f32 v155, v155
  v_mul_f32 v152, v152, v176
  v_mul_f32 v154, v154, v178
  v_mul_f32 v153, v153, v177
  v_mul_f32 v155, v155, v179
  v_cvt_pk_bf16_f32 v6, v152, v153
  v_cvt_pk_bf16_f32 v3, v154, v155
  v_lshlrev_b32 v152, 16, v6
  v_lshlrev_b32 v154, 16, v3
  v_and_b32 v153, s15, v6
  v_and_b32 v155, s15, v3
  v_mul_f32 v152, v152, v80
  v_mul_f32 v154, v154, v82
  v_mul_f32 v153, v153, v81
  v_mul_f32 v155, v155, v83
  v_cvt_pk_bf16_f32 v6, v152, v153
  v_cvt_pk_bf16_f32 v3, v154, v155
  v_lshlrev_b32 v152, 16, v6
  v_lshlrev_b32 v154, 16, v3
  v_and_b32 v153, s15, v6
  v_and_b32 v155, s15, v3
  v_add_f32 v152, v152, v96
  v_add_f32 v154, v154, v98
  v_add_f32 v153, v153, v97
  v_add_f32 v155, v155, v99
  v_cvt_pk_bf16_f32 v164, v152, v153
  v_cvt_pk_bf16_f32 v165, v154, v155
  buffer_store_dwordx2 v[164:165], v64, s[76:79], s3 offen
Lh19:
  ds_read_b32 v8, v10 offset:116
  s_waitcnt lgkmcnt(0)
  v_cmp_gt_u32 vcc, 4, v8
  s_cbranch_vccz Lh19_x
  s_sleep 1
  s_sub_u32 s30, s30, 1
  s_cmp_gt_i32 s30, 0
  s_cbranch_scc1 Lh19
Lh19_x:
  ds_read_b128 v[176:179], v70 offset:16384
  ds_read_b128 v[180:183], v70 offset:17408
  ds_read_b128 v[184:187], v70 offset:18432
  ds_read_b128 v[188:191], v70 offset:19456
  s_mov_b32 s3, 16384
  s_waitcnt lgkmcnt(0)
  v_add_f32 v176, v176, v180
  v_add_f32 v178, v178, v182
  v_add_f32 v177, v177, v181
  v_add_f32 v179, v179, v183
  v_add_f32 v152, v184, v188
  v_add_f32 v154, v186, v190
  v_add_f32 v153, v185, v189
  v_add_f32 v155, v187, v191
  v_add_f32 v176, v176, v152
  v_add_f32 v178, v178, v154
  v_add_f32 v177, v177, v153
  v_add_f32 v179, v179, v155
  v_cvt_pk_bf16_f32 v6, v176, v177
  v_cvt_pk_bf16_f32 v3, v178, v179
  v_lshlrev_b32 v176, 16, v6
  v_lshlrev_b32 v178, 16, v3
  v_and_b32 v177, s15, v6
  v_and_b32 v179, s15, v3
  v_add_f32 v176, v176, v104
  v_add_f32 v178, v178, v106
  v_add_f32 v177, v177, v105
  v_add_f32 v179, v179, v107
  v_cvt_pk_bf16_f32 v6, v176, v177
  v_cvt_pk_bf16_f32 v3, v178, v179
  v_lshlrev_b32 v176, 16, v6
  v_lshlrev_b32 v178, 16, v3
  v_and_b32 v177, s15, v6
  v_and_b32 v179, s15, v3
  v_mul_f32 v152, s4, v176
  v_mul_f32 v154, s4, v178
  v_mul_f32 v153, s4, v177
  v_mul_f32 v155, s4, v179
  v_exp_f32 v152, v152
  v_exp_f32 v154, v154
  v_exp_f32 v153, v153
  v_exp_f32 v155, v155
  v_add_f32 v152, 1.0, v152
  v_add_f32 v154, 1.0, v154
  v_add_f32 v153, 1.0, v153
  v_add_f32 v155, 1.0, v155
  v_rcp_f32 v152, v152
  v_rcp_f32 v154, v154
  v_rcp_f32 v153, v153
  v_rcp_f32 v155, v155
  v_mul_f32 v152, v152, v176
  v_mul_f32 v154, v154, v178
  v_mul_f32 v153, v153, v177
  v_mul_f32 v155, v155, v179
  v_cvt_pk_bf16_f32 v6, v152, v153
  v_cvt_pk_bf16_f32 v3, v154, v155
  v_lshlrev_b32 v152, 16, v6
  v_lshlrev_b32 v154, 16, v3
  v_and_b32 v153, s15, v6
  v_and_b32 v155, s15, v3
  v_mul_f32 v152, v152, v76
  v_mul_f32 v154, v154, v78
  v_mul_f32 v153, v153, v77
  v_mul_f32 v155, v155, v79
  v_cvt_pk_bf16_f32 v6, v152, v153
  v_cvt_pk_bf16_f32 v3, v154, v155
  v_lshlrev_b32 v152, 16, v6
  v_lshlrev_b32 v154, 16, v3
  v_and_b32 v153, s15, v6
  v_and_b32 v155, s15, v3
  v_add_f32 v152, v152, v92
  v_add_f32 v154, v154, v94
  v_add_f32 v153, v153, v93
  v_add_f32 v155, v155, v95
  v_cvt_pk_bf16_f32 v162, v152, v153
  v_cvt_pk_bf16_f32 v163, v154, v155
  buffer_store_dwordx2 v[162:163], v64, s[76:79], s3 offen
Lh20:
  ds_read_b32 v8, v10 offset:124
  s_waitcnt lgkmcnt(0)
  v_cmp_gt_u32 vcc, 4, v8
  s_cbranch_vccz Lh20_x
  s_sub_u32 s30, s30, 1
  s_cmp_gt_i32 s30, 0
  s_cbranch_scc1 Lh20
Lh20_x:
  ds_read_b128 v[176:179], v70 offset:32768
  ds_read_b128 v[180:183], v70 offset:33792
  ds_read_b128 v[184:187], v70 offset:34816
  ds_read_b128 v[188:191], v70 offset:35840
  s_mov_b32 s3, 49152
  s_waitcnt lgkmcnt(0)
  v_add_f32 v176, v176, v180
  v_add_f32 v178, v178, v182
  v_add_f32 v177, v177, v181
  v_add_f32 v179, v179, v183
  v_add_f32 v152, v184, v188
  v_add_f32 v154, v186, v190
  v_add_f32 v153, v185, v189
  v_add_f32 v155, v187, v191
  v_add_f32 v176, v176, v152
  v_add_f32 v178, v178, v154
  v_add_f32 v177, v177, v153
  v_add_f32 v179, v179, v155
  v_cvt_pk_bf16_f32 v6, v176, v177
  v_cvt_pk_bf16_f32 v3, v178, v179
  v_lshlrev_b32 v176, 16, v6
  v_lshlrev_b32 v178, 16, v3
  v_and_b32 v177, s15, v6
  v_and_b32 v179, s15, v3
  v_add_f32 v176, v176, v104
  v_add_f32 v178, v178, v106
  v_add_f32 v177, v177, v105
  v_add_f32 v179, v179, v107
  v_cvt_pk_bf16_f32 v6, v176, v177
  v_cvt_pk_bf16_f32 v3, v178, v179
  v_lshlrev_b32 v176, 16, v6
  v_lshlrev_b32 v178, 16, v3
  v_and_b32 v177, s15, v6
  v_and_b32 v179, s15, v3
  v_mul_f32 v152, s4, v176
  v_mul_f32 v154, s4, v178
  v_mul_f32 v153, s4, v177
  v_mul_f32 v155, s4, v179
  v_exp_f32 v152, v152
  v_exp_f32 v154, v154
  v_exp_f32 v153, v153
  v_exp_f32 v155, v155
  v_add_f32 v152, 1.0, v152
  v_add_f32 v154, 1.0, v154
  v_add_f32 v153, 1.0, v153
  v_add_f32 v155, 1.0, v155
  v_rcp_f32 v152, v152
  v_rcp_f32 v154, v154
  v_rcp_f32 v153, v153
  v_rcp_f32 v155, v155
  v_mul_f32 v152, v152, v176
  v_mul_f32 v154, v154, v178
  v_mul_f32 v153, v153, v177
  v_mul_f32 v155, v155, v179
  v_cvt_pk_bf16_f32 v6, v152, v153
  v_cvt_pk_bf16_f32 v3, v154, v155
  v_lshlrev_b32 v152, 16, v6
  v_lshlrev_b32 v154, 16, v3
  v_and_b32 v153, s15, v6
  v_and_b32 v155, s15, v3
  v_mul_f32 v152, v152, v84
  v_mul_f32 v154, v154, v86
  v_mul_f32 v153, v153, v85
  v_mul_f32 v155, v155, v87
  v_cvt_pk_bf16_f32 v6, v152, v153
  v_cvt_pk_bf16_f32 v3, v154, v155
  v_lshlrev_b32 v152, 16, v6
  v_lshlrev_b32 v154, 16, v3
  v_and_b32 v153, s15, v6
  v_and_b32 v155, s15, v3
  v_add_f32 v152, v152, v100
  v_add_f32 v154, v154, v102
  v_add_f32 v153, v153, v101
  v_add_f32 v155, v155, v103
  v_cvt_pk_bf16_f32 v166, v152, v153
  v_cvt_pk_bf16_f32 v167, v154, v155
  buffer_store_dwordx2 v[166:167], v64, s[76:79], s3 offen
  s_endpgm
L_done:
  s_endpgm
.set CODE_SPAN, L_done - recurrent_scan__ssm_conv_h3__mixer_channel_mlp__prompt_kernel - 512
.section .rodata,"a"
.p2align 6
.amdhsa_kernel recurrent_scan__ssm_conv_h3__mixer_channel_mlp__prompt_kernel
  .amdhsa_next_free_vgpr 256
  .amdhsa_next_free_sgpr 102
  .amdhsa_accum_offset 256
  .amdhsa_group_segment_fixed_size 0
  .amdhsa_kernarg_size 112
  .amdhsa_user_sgpr_count 2
  .amdhsa_user_sgpr_kernarg_segment_ptr 1
  .amdhsa_system_sgpr_workgroup_id_x 1
.end_amdhsa_kernel
```
